```python
import torch

def _softmax(x, axis=-1):
    return torch.softmax(x, dim=axis)

def _gelu(x):
    return torch.nn.functional.gelu(x, approximate='tanh')

def _silu(x):
    return torch.nn.functional.silu(x)

def _sigmoid(x):
    return torch.sigmoid(x)

def _layernorm(x, axis=-1, eps=1e-05):
    m = x.mean(dim=axis, keepdim=True)
    v = x.var(dim=axis, keepdim=True, unbiased=False)
    return (x - m) / torch.sqrt(v + eps)

def _scatter_add(tgt, idx, src, axis=0):
    return tgt.clone().index_add_(axis, idx, src)

def _segment_sum(src, seg, n):
    out = torch.zeros((n,) + src.shape[1:], dtype=src.dtype)
    return out.index_add_(0, seg, src)

def _pad(x, pw):
    flat = tuple((v for pair in reversed(pw) for v in pair))
    return torch.nn.functional.pad(x, flat)
kernel_name = 'adaLN_cond__gqa_block_cached__glu_gated_bilinear__decode'

def setup_inputs():

    _w = lambda a: (lambda t: t.to(torch.bfloat16) if t.is_floating_point() else t)(torch.as_tensor(a))

    def _A_setup():
        B, Sq, D = (4, 1, 640)
        Hq, Hkv, Sk, Dh = (32, 32, 4096, 192)
        assert Hq % Hkv == 0, (Hq, Hkv)
        return {'x': _w((lambda *s: torch.randn(*s, dtype=torch.bfloat16) * 0.1)(B, Sq, D)), 'k_cache': _w((lambda *s: torch.randn(*s, dtype=torch.bfloat16) * 0.8)(B, Hkv, Sk, Dh)), 'v_cache': _w((lambda *s: torch.randn(*s, dtype=torch.bfloat16) * 3.2)(B, Hkv, Sk, Dh)), 'wq': _w((lambda *s: torch.randn(*s, dtype=torch.bfloat16) * 0.8)(D, Hq * Dh) * D ** (-0.5)), 'wo': _w((lambda *s: torch.randn(*s, dtype=torch.bfloat16) * 3.2)(Hq * Dh, D) * (Hq * Dh) ** (-0.5))}
    _A_in = _A_setup()

    def _B_setup():
        B, S, D, F = (4, 1, 640, 1536)
        return {'x': _w((lambda *s: torch.randn(*s, dtype=torch.bfloat16) * 0.1)(B, S, D)), 'w_gate': _w((lambda *s: torch.randn(*s, dtype=torch.bfloat16) * 3.2)(D, F) * D ** (-0.5)), 'w_up': _w((lambda *s: torch.randn(*s, dtype=torch.bfloat16) * 3.2)(D, F) * D ** (-0.5)), 'w_down': _w((lambda *s: torch.randn(*s, dtype=torch.bfloat16) * 3.2)(F, D) * F ** (-0.5))}
    _B_in = _B_setup()
    return {'A_x': _A_in['x'], 'A_k_cache': _A_in['k_cache'], 'A_v_cache': _A_in['v_cache'], 'A_wq': _A_in['wq'], 'A_wo': _A_in['wo'], 'B_x': _B_in['x'], 'B_w_gate': _B_in['w_gate'], 'B_w_up': _B_in['w_up'], 'B_w_down': _B_in['w_down'], 'c': _w((lambda *s: torch.randn(*s, dtype=torch.bfloat16) * 0.4)(4, 640) * 8.0), 'w_mod': _w((lambda *s: torch.randn(*s, dtype=torch.bfloat16) * 0.4)(640, 6 * 640) * 640 ** (-0.5) * 8.0)}

def reference(A_x, A_k_cache, A_v_cache, A_wq, A_wo, B_x, B_w_gate, B_w_up, B_w_down, c, w_mod):

    def _A_ref(x, k_cache, v_cache, wq, wo):
        B, Sq, D = x.shape
        Hq, Dh = (32, 192)
        Hkv = k_cache.shape[1]
        rep = Hq // Hkv
        q = (lambda x, *d: x.permute(*d))((x @ wq).reshape(B, Sq, Hq, Dh), 0, 2, 1, 3)
        k = (lambda x, n, axis: torch.repeat_interleave(x, n, dim=axis))(k_cache, rep, axis=1)
        v = (lambda x, n, axis: torch.repeat_interleave(x, n, dim=axis))(v_cache, rep, axis=1)
        scores = torch.einsum('bhqd,bhkd->bhqk', q, k) * Dh ** (-0.5)
        p = _softmax(scores, axis=-1)
        o = torch.einsum('bhqk,bhkd->bhqd', p, v)
        return (lambda x, *d: x.permute(*d))(o, 0, 2, 1, 3).reshape(B, Sq, Hq * Dh) @ wo

    def _B_ref(x, w_gate, w_up, w_down):
        g = torch.einsum('bsd,df->bsf', x, w_gate)
        u = torch.einsum('bsd,df->bsf', x, w_up)
        h = g * u
        return torch.einsum('bsf,fd->bsd', h, w_down)
    x = A_x
    mod = (_silu(c) @ w_mod).reshape(c.shape[0], 6, 1, -1)
    sa, ca, ga, sb, cb, gb = (mod[:, 0].clone(), mod[:, 1].clone(), mod[:, 2].clone(), mod[:, 3].clone(), mod[:, 4].clone(), mod[:, 5].clone())
    h = _layernorm(x, axis=-1) * (1 + ca) + sa
    x = x + ga * _A_ref(h, A_k_cache, A_v_cache, A_wq, A_wo)
    h = _layernorm(x, axis=-1) * (1 + cb) + sb
    x = x + gb * _B_ref(h, B_w_gate, B_w_up, B_w_down)
    return x
```

```asm
; @launch grid=(256,1,1) block=(768,1,1) lds=152576
.amdgcn_target "amdgcn-amd-amdhsa--gfx950"
.text
.globl adaLN_cond__gqa_block_cached__glu_gated_bilinear__decode_kernel
.p2align 8
.type adaLN_cond__gqa_block_cached__glu_gated_bilinear__decode_kernel,@function
adaLN_cond__gqa_block_cached__glu_gated_bilinear__decode_kernel:
  s_cmp_ge_u32 s2, 256
  s_cbranch_scc1 L_end
  s_load_dwordx16 s[4:19], s[0:1], 0
  s_load_dwordx8 s[20:27], s[0:1], 64
  s_load_dwordx4 s[28:31], s[0:1], 96
  v_lshrrev_b32 v1, 6, v0
  v_and_b32 v5, 63, v0
  v_readfirstlane_b32 s44, v1
  s_lshr_b32 s45, s2, 1
  s_mov_b32 s80, 2
  s_bitcmp1_b32 s2, 0
  s_cbranch_scc1 L_early_q
  s_sub_u32 s81, s45, 4
  s_cmp_lt_u32 s81, 60
  s_cselect_b32 s80, 1, 0
  s_cmp_lt_u32 s45, 64
  s_cbranch_scc1 L_early_done
  s_mov_b32 s80, 2
  s_add_u32 s45, s45, 64
L_early_q:
  s_lshr_b32 s81, s45, 1
  s_and_b32 s89, s45, 1
L_early_done:
  s_cmp_lt_u32 s44, 4
  s_cbranch_scc0 L_stream
L_helper:
  s_setprio 2
  v_lshrrev_b32 v17, 4, v5
  v_and_b32 v18, 15, v5
  s_cmp_eq_u32 s80, 1
  s_cbranch_scc0 L_hq0
  v_lshrrev_b32 v6, 3, v5
  v_bfe_u32 v7, v5, 4, 1
  v_lshlrev_b32 v7, 5, v7
  v_and_b32 v8, 7, v5
  v_lshlrev_b32 v8, 4, v8
  v_xor_b32 v8, v8, v7
  v_xor_b32 v9, 64, v8
  s_mov_b32 s45, 7680
  v_mul_lo_u32 v6, s45, v6
  v_add_u32 v8, v8, v6
  v_add_u32 v9, v9, v6
  s_mul_i32 s46, s44, 1228800
  s_lshl_b32 s85, s81, 7
  s_mul_i32 s47, s44, 20480
  s_add_u32 s47, s47, 29184
  v_mul_u32_u24 v16, 1280, v17
  v_mad_u32_u24 v16, v18, 20, v16
  s_mul_i32 s63, s44, 320
  s_waitcnt lgkmcnt(0)
  s_mov_b32 s36, s22
  s_mov_b32 s37, s23
  s_mov_b32 s38, 5120
  s_mov_b32 s39, 0x20000
  s_add_u32 s32, s24, s85
  s_addc_u32 s33, s25, 0
  s_mov_b32 s34, 4915200
  s_mov_b32 s35, 0x20000
  buffer_load_dwordx4 v[30:33], v16, s[36:39], s63 offen
  buffer_load_dword v34, v16, s[36:39], s63 offen offset:16
  s_mov_b32 s85, 10
L_mod_dma:
  s_mov_b32 m0, s47
  s_add_u32 s47, s47, 1024
  buffer_load_dwordx4 v8, s[32:35], s46 offen nt lds
  s_add_u32 s46, s46, 61440
  s_mov_b32 m0, s47
  s_add_u32 s47, s47, 1024
  buffer_load_dwordx4 v9, s[32:35], s46 offen nt lds
  s_add_u32 s46, s46, 61440
  s_sub_u32 s85, s85, 1
  s_cmp_lg_u32 s85, 0
  s_cbranch_scc1 L_mod_dma
  s_branch L_modrest
L_hq0:
  s_cmp_eq_u32 s80, 2
  s_cbranch_scc0 L_hnone
  v_lshrrev_b32 v6, 3, v5
  v_bfe_u32 v7, v5, 4, 1
  v_lshlrev_b32 v7, 5, v7
  v_and_b32 v8, 7, v5
  v_lshlrev_b32 v8, 4, v8
  v_xor_b32 v8, v8, v7
  v_xor_b32 v9, 64, v8
  s_mov_b32 s45, 12288
  v_mul_lo_u32 v6, s45, v6
  v_add_u32 v8, v8, v6
  v_add_u32 v9, v9, v6
  s_mul_i32 s46, s44, 983040
  s_mul_i32 s47, s89, 3932160
  s_lshl_b32 s45, s81, 7
  s_add_u32 s85, s47, s45
  s_mul_i32 s47, s44, 10240
  s_add_u32 s47, s47, 29184
  v_min_u32 v18, 9, v18
  v_mul_u32_u24 v16, 1280, v17
  v_lshl_add_u32 v16, v18, 4, v16
  s_mul_i32 s63, s89, 640
  s_mul_i32 s45, s44, 160
  s_add_u32 s63, s63, s45
  v_lshlrev_b32 v19, 2, v5
  s_mul_i32 s48, s44, 1280
  s_waitcnt lgkmcnt(0)
  s_mov_b32 s36, s4
  s_mov_b32 s37, s5
  s_mov_b32 s38, 5120
  s_mov_b32 s39, 0x20000
  s_add_u32 s32, s10, s85
  s_addc_u32 s33, s11, 0
  s_mov_b32 s34, 3932160
  s_mov_b32 s35, 0x20000
  buffer_load_dword v35, v19, s[36:39], s48 offen offset:0
  buffer_load_dword v36, v19, s[36:39], s48 offen offset:256
  buffer_load_dword v37, v19, s[36:39], s48 offen offset:512
  buffer_load_dword v38, v19, s[36:39], s48 offen offset:768
  buffer_load_dword v39, v19, s[36:39], s48 offen offset:1024
  buffer_load_dwordx4 v[28:31], v16, s[36:39], s63 offen
  s_mov_b32 s85, 5
L_q_dma:
  s_mov_b32 m0, s47
  s_add_u32 s47, s47, 1024
  buffer_load_dwordx4 v8, s[32:35], s46 offen nt lds
  s_add_u32 s46, s46, 98304
  s_mov_b32 m0, s47
  s_add_u32 s47, s47, 1024
  buffer_load_dwordx4 v9, s[32:35], s46 offen nt lds
  s_add_u32 s46, s46, 98304
  s_sub_u32 s85, s85, 1
  s_cmp_lg_u32 s85, 0
  s_cbranch_scc1 L_q_dma
  s_branch L_qrest
L_stream:
  s_cmp_eq_u32 s44, 11
  s_cbranch_scc0 L_noprio
  s_setprio 3
L_noprio:
  s_and_b32 s59, s2, 1
  s_xor_b32 s45, s2, 5
  s_cmp_eq_u32 s59, 0
  s_cselect_b32 s45, s2, s45
  s_bfe_u32 s45, s45, 0x20001
  s_lshr_b32 s46, s2, 3
  s_lshr_b32 s57, s46, 3
  s_and_b32 s46, s46, 7
  s_lshl_b32 s46, s46, 2
  s_add_u32 s58, s46, s45
  s_mov_b32 s82, 0
  s_lshr_b32 s45, s2, 1
  s_mul_i32 s46, s45, 6554
  s_lshr_b32 s46, s46, 16
  s_mov_b32 s84, s46
  s_mul_i32 s47, s46, 10
  s_sub_u32 s83, s45, s47
  s_cmp_lt_u32 s45, 80
  s_cselect_b32 s82, 1, 0
  s_bitcmp1_b32 s2, 0
  s_cbranch_scc0 L_roles_done_1
  s_mov_b32 s83, s45
  s_cmp_lt_u32 s45, 48
  s_cselect_b32 s82, 2, 0
L_roles_done_1:
  s_waitcnt lgkmcnt(0)
  s_mov_b32 s40, s30
  s_mov_b32 s41, s31
  s_mov_b32 s42, 2097152
  s_mov_b32 s43, 0x20000
  s_cmp_eq_u32 s44, 11
  s_cbranch_scc0 L_noreset
  v_mov_b32 v8, -1
  v_mov_b32 v9, -1
  v_mov_b32 v10, -1
  v_mov_b32 v11, -1
  v_lshlrev_b32 v6, 4, v5
  s_lshl_b32 s45, s57, 5
  s_add_u32 s45, s45, s58
  s_lshl_b32 s45, s45, 1
  s_add_u32 s45, s45, s59
  s_mul_i32 s45, s45, 768
  s_add_u32 s45, s45, 262144
  s_mov_b32 exec_lo, -1
  s_mov_b32 exec_hi, 0xffff
  buffer_store_dwordx4 v[8:11], v6, s[40:43], s45 offen sc1
  s_lshl_b32 s45, s2, 7
  s_add_u32 s45, s45, 229376
  s_mov_b64 exec, 0x11
  buffer_store_dwordx4 v[8:11], v6, s[40:43], s45 offen sc1
  s_mov_b64 exec, -1
  v_lshrrev_b32 v7, 4, v5
  v_and_b32 v12, 15, v5
  v_lshlrev_b32 v12, 4, v12
  s_cmp_eq_u32 s80, 2
  s_cbranch_scc0 L_rs2
  v_mul_u32_u24 v13, 24576, v7
  v_add_u32 v13, v13, v12
  s_mul_i32 s45, s81, 256
  s_mul_i32 s46, s89, 98304
  s_add_u32 s45, s45, s46
  s_add_u32 s45, s45, 32768
  s_mov_b32 exec_lo, 0xffffffff
  s_mov_b32 exec_hi, 0xffffffff
  buffer_store_dwordx4 v[8:11], v13, s[40:43], s45 offen sc1
  s_mov_b64 exec, -1
L_rs2:
  s_cmp_eq_u32 s80, 1
  s_cbranch_scc0 L_rs1
  v_mul_u32_u24 v13, 7680, v7
  v_add_u32 v13, v13, v12
  s_mul_i32 s45, s81, 128
  s_add_u32 s45, s45, 0
  s_mov_b32 exec_lo, 0xff00ff
  s_mov_b32 exec_hi, 0xff00ff
  buffer_store_dwordx4 v[8:11], v13, s[40:43], s45 offen sc1
  s_mov_b64 exec, -1
L_rs1:
  s_cmp_eq_u32 s82, 1
  s_cbranch_scc0 L_rs3
  v_mul_u32_u24 v13, 2560, v7
  v_add_u32 v13, v13, v12
  s_mul_i32 s45, s83, 256
  s_mul_i32 s46, s84, 10240
  s_add_u32 s45, s45, s46
  s_add_u32 s45, s45, 458752
  s_mov_b32 exec_lo, 0xffffffff
  s_mov_b32 exec_hi, 0xffffffff
  buffer_store_dwordx4 v[8:11], v13, s[40:43], s45 offen sc1
  s_mov_b64 exec, -1
L_rs3:
  s_cmp_eq_u32 s82, 2
  s_cbranch_scc0 L_rs4
  v_mul_u32_u24 v13, 12288, v7
  v_add_u32 v13, v13, v12
  s_lshl_b32 s45, s83, 8
  s_add_u32 s45, s45, 540672
  buffer_store_dwordx4 v[8:11], v13, s[40:43], s45 offen sc1
  s_add_u32 s45, s45, 49152
  buffer_store_dwordx4 v[8:11], v13, s[40:43], s45 offen sc1
  s_add_u32 s45, s45, 49152
  buffer_store_dwordx4 v[8:11], v13, s[40:43], s45 offen sc1
  s_add_u32 s45, s45, 49152
  buffer_store_dwordx4 v[8:11], v13, s[40:43], s45 offen sc1
  s_add_u32 s45, s45, 49152
  buffer_store_dwordx4 v[8:11], v13, s[40:43], s45 offen sc1
  s_add_u32 s45, s45, 49152
  buffer_store_dwordx4 v[8:11], v13, s[40:43], s45 offen sc1
  s_add_u32 s45, s45, 49152
  buffer_store_dwordx4 v[8:11], v13, s[40:43], s45 offen sc1
  s_add_u32 s45, s45, 49152
  buffer_store_dwordx4 v[8:11], v13, s[40:43], s45 offen sc1
  s_add_u32 s45, s45, 49152
  buffer_store_dwordx4 v[8:11], v13, s[40:43], s45 offen sc1
  s_add_u32 s45, s45, 49152
  buffer_store_dwordx4 v[8:11], v13, s[40:43], s45 offen sc1
L_rs4:
  s_waitcnt vmcnt(0)
  s_mov_b64 exec, 1
  v_mov_b32 v8, 1
  s_and_b32 s45, s2, 1
  s_lshl_b32 s45, s45, 7
  v_mov_b32 v9, s45
  global_atomic_add v9, v8, s[28:29] sc1
  s_cmp_eq_u32 s80, 1
  s_cbranch_scc0 L_noc1
  s_cmp_lt_u32 s81, 20
  s_cbranch_scc0 L_noc1
  v_mov_b32 v9, 132
  global_atomic_add v9, v8, s[28:29] sc1
L_noc1:
  s_mov_b64 exec, -1
  s_setprio 0
L_noreset:
  s_nop 1
  s_sub_u32 s44, s44, 4
  s_lshl_b32 s45, s57, 5
  s_add_u32 s45, s45, s58
  s_mul_i32 s45, s45, 1572864
  s_mul_i32 s46, s59, 811008
  s_add_u32 s47, s45, s46
  s_add_u32 s32, s6, s47
  s_addc_u32 s33, s7, 0
  s_mov_b32 s34, 811008
  s_mov_b32 s35, 0x20000
  s_add_u32 s36, s8, s47
  s_addc_u32 s37, s9, 0
  s_mov_b32 s38, 811008
  s_mov_b32 s39, 0x20000
  s_cmp_eq_u32 s59, 0
  s_mov_b32 s45, 811008
  s_cselect_b32 s34, s45, 761856
  s_mov_b32 s38, s34
  s_branch L_stream_main
L_hnone:
  s_lshl_b32 s45, s44, 2
  s_add_u32 s45, s45, 17664
  v_mov_b32 v6, s45
  v_mov_b32 v7, 0
  ds_write_b32 v6, v7
  s_waitcnt lgkmcnt(0)
  s_mov_b32 s40, s30
  s_mov_b32 s41, s31
  s_mov_b32 s42, 2097152
  s_mov_b32 s43, 0x20000
  s_barrier
  s_cmp_eq_u32 s44, 1
  s_cbranch_scc0 L_notmaster
  s_cmp_eq_u32 s2, 0
  s_cbranch_scc0 L_notmaster
  v_lshlrev_b32 v7, 7, v5
  v_mov_b32 v6, 132
  v_cmp_eq_u32 vcc, 2, v5
  s_nop 1
  v_cndmask_b32 v7, v7, v6, vcc
  s_mov_b32 s62, 0
  s_mov_b32 s63, 0
L_master:
  s_mov_b64 exec, 7
  global_load_dword v6, v7, s[28:29] sc1
  s_add_u32 s62, s62, 1
  s_waitcnt vmcnt(0)
  v_readlane_b32 s45, v6, 0
  v_readlane_b32 s46, v6, 1
  v_readlane_b32 s47, v6, 2
  s_min_u32 s45, s45, s46
  s_cmp_ge_u32 s45, 128
  s_cbranch_scc1 L_master_ok
  s_cmp_lt_u32 s47, 20
  s_cbranch_scc1 L_master_next
  s_cmp_eq_u32 s63, 0
  s_cbranch_scc0 L_master_next
  s_mov_b32 s63, 1
  s_mov_b64 exec, -1
  v_lshlrev_b32 v8, 7, v5
  v_mov_b32 v9, 1
  s_mov_b32 s45, 229440
  buffer_store_dword v9, v8, s[40:43], s45 offen sc1
  s_mov_b32 s45, 237632
  buffer_store_dword v9, v8, s[40:43], s45 offen sc1
  s_mov_b32 s45, 245824
  buffer_store_dword v9, v8, s[40:43], s45 offen sc1
  s_mov_b32 s45, 254016
  buffer_store_dword v9, v8, s[40:43], s45 offen sc1
L_master_next:
  s_cmp_lt_u32 s62, 65536
  s_cbranch_scc1 L_master
L_master_ok:
  s_mov_b64 exec, -1
  v_lshlrev_b32 v8, 7, v5
  v_mov_b32 v9, 2
  s_mov_b32 s45, 229440
  buffer_store_dword v9, v8, s[40:43], s45 offen sc1
  s_mov_b32 s45, 237632
  buffer_store_dword v9, v8, s[40:43], s45 offen sc1
  s_mov_b32 s45, 245824
  buffer_store_dword v9, v8, s[40:43], s45 offen sc1
  s_mov_b32 s45, 254016
  buffer_store_dword v9, v8, s[40:43], s45 offen sc1
  s_mov_b64 exec, -1
L_notmaster:
  s_cmp_eq_u32 s2, 0
  s_cbranch_scc0 L_h_go
  s_barrier
  s_branch L_h_go
L_modrest:
  s_nop 1
  s_lshl_b32 s45, s44, 2
  s_add_u32 s45, s45, 17664
  v_mov_b32 v6, s45
  v_mov_b32 v7, 0
  ds_write_b32 v6, v7
  s_mov_b32 s40, s30
  s_mov_b32 s41, s31
  s_mov_b32 s42, 2097152
  s_mov_b32 s43, 0x20000
  s_mov_b32 s54, 0x3fb8aa3b
  s_mul_i32 s47, s44, 320
  s_add_u32 s47, s47, 0
  v_mul_u32_u24 v40, 1344, v17
  v_mad_u32_u24 v40, v18, 20, v40
  v_add_u32 v40, s47, v40
  s_waitcnt vmcnt(20)
  v_lshlrev_b32 v46, 16, v30
  v_and_b32 v47, 0xffff0000, v30
  v_mul_f32 v48, s54, v46
  v_exp_f32 v48, -v48
  s_nop 0
  v_add_f32 v48, 1.0, v48
  v_min_f32 v48, 0x7f7fffff, v48
  v_rcp_f32 v49, v48
  s_nop 0
  v_mul_f32 v50, v46, v49
  v_fma_f32 v46, -v50, v48, v46
  v_fma_f32 v46, v46, v49, v50
  v_mul_f32 v48, s54, v47
  v_exp_f32 v48, -v48
  s_nop 0
  v_add_f32 v48, 1.0, v48
  v_min_f32 v48, 0x7f7fffff, v48
  v_rcp_f32 v49, v48
  s_nop 0
  v_mul_f32 v50, v47, v49
  v_fma_f32 v47, -v50, v48, v47
  v_fma_f32 v47, v47, v49, v50
  v_cvt_pk_bf16_f32 v46, v46, v47
  ds_write_b32 v40, v46 offset:0
  v_lshlrev_b32 v46, 16, v31
  v_and_b32 v47, 0xffff0000, v31
  v_mul_f32 v48, s54, v46
  v_exp_f32 v48, -v48
  s_nop 0
  v_add_f32 v48, 1.0, v48
  v_min_f32 v48, 0x7f7fffff, v48
  v_rcp_f32 v49, v48
  s_nop 0
  v_mul_f32 v50, v46, v49
  v_fma_f32 v46, -v50, v48, v46
  v_fma_f32 v46, v46, v49, v50
  v_mul_f32 v48, s54, v47
  v_exp_f32 v48, -v48
  s_nop 0
  v_add_f32 v48, 1.0, v48
  v_min_f32 v48, 0x7f7fffff, v48
  v_rcp_f32 v49, v48
  s_nop 0
  v_mul_f32 v50, v47, v49
  v_fma_f32 v47, -v50, v48, v47
  v_fma_f32 v47, v47, v49, v50
  v_cvt_pk_bf16_f32 v46, v46, v47
  ds_write_b32 v40, v46 offset:4
  v_lshlrev_b32 v46, 16, v32
  v_and_b32 v47, 0xffff0000, v32
  v_mul_f32 v48, s54, v46
  v_exp_f32 v48, -v48
  s_nop 0
  v_add_f32 v48, 1.0, v48
  v_min_f32 v48, 0x7f7fffff, v48
  v_rcp_f32 v49, v48
  s_nop 0
  v_mul_f32 v50, v46, v49
  v_fma_f32 v46, -v50, v48, v46
  v_fma_f32 v46, v46, v49, v50
  v_mul_f32 v48, s54, v47
  v_exp_f32 v48, -v48
  s_nop 0
  v_add_f32 v48, 1.0, v48
  v_min_f32 v48, 0x7f7fffff, v48
  v_rcp_f32 v49, v48
  s_nop 0
  v_mul_f32 v50, v47, v49
  v_fma_f32 v47, -v50, v48, v47
  v_fma_f32 v47, v47, v49, v50
  v_cvt_pk_bf16_f32 v46, v46, v47
  ds_write_b32 v40, v46 offset:8
  v_lshlrev_b32 v46, 16, v33
  v_and_b32 v47, 0xffff0000, v33
  v_mul_f32 v48, s54, v46
  v_exp_f32 v48, -v48
  s_nop 0
  v_add_f32 v48, 1.0, v48
  v_min_f32 v48, 0x7f7fffff, v48
  v_rcp_f32 v49, v48
  s_nop 0
  v_mul_f32 v50, v46, v49
  v_fma_f32 v46, -v50, v48, v46
  v_fma_f32 v46, v46, v49, v50
  v_mul_f32 v48, s54, v47
  v_exp_f32 v48, -v48
  s_nop 0
  v_add_f32 v48, 1.0, v48
  v_min_f32 v48, 0x7f7fffff, v48
  v_rcp_f32 v49, v48
  s_nop 0
  v_mul_f32 v50, v47, v49
  v_fma_f32 v47, -v50, v48, v47
  v_fma_f32 v47, v47, v49, v50
  v_cvt_pk_bf16_f32 v46, v46, v47
  ds_write_b32 v40, v46 offset:12
  v_lshlrev_b32 v46, 16, v34
  v_and_b32 v47, 0xffff0000, v34
  v_mul_f32 v48, s54, v46
  v_exp_f32 v48, -v48
  s_nop 0
  v_add_f32 v48, 1.0, v48
  v_min_f32 v48, 0x7f7fffff, v48
  v_rcp_f32 v49, v48
  s_nop 0
  v_mul_f32 v50, v46, v49
  v_fma_f32 v46, -v50, v48, v46
  v_fma_f32 v46, v46, v49, v50
  v_mul_f32 v48, s54, v47
  v_exp_f32 v48, -v48
  s_nop 0
  v_add_f32 v48, 1.0, v48
  v_min_f32 v48, 0x7f7fffff, v48
  v_rcp_f32 v49, v48
  s_nop 0
  v_mul_f32 v50, v47, v49
  v_fma_f32 v47, -v50, v48, v47
  v_fma_f32 v47, v47, v49, v50
  v_cvt_pk_bf16_f32 v46, v46, v47
  ds_write_b32 v40, v46 offset:16
  v_lshrrev_b32 v6, 4, v5
  v_bfe_u32 v7, v5, 2, 2
  v_lshl_add_u32 v10, v6, 3, v7
  v_lshlrev_b32 v10, 7, v10
  v_and_b32 v6, 1, v6
  v_lshlrev_b32 v6, 6, v6
  v_bfe_u32 v7, v5, 3, 1
  v_lshlrev_b32 v7, 5, v7
  v_or3_b32 v10, v10, v6, v7
  v_and_b32 v6, 3, v5
  v_lshl_add_u32 v10, v6, 3, v10
  s_lshl_b32 s45, s44, 5
  v_xor_b32 v10, s45, v10
  v_add_u32 v10, 29184, v10
  v_add_u32 v11, 40960, v10
  v_and_b32 v6, 3, v5
  v_mul_u32_u24 v14, 1344, v6
  v_lshrrev_b32 v6, 4, v5
  v_lshl_add_u32 v14, v6, 4, v14
  s_waitcnt vmcnt(0) lgkmcnt(0)
  s_barrier
  ds_read_b64_tr_b16 v[80:81], v10 offset:0
  ds_read_b64_tr_b16 v[82:83], v10 offset:512
  ds_read_b128 v[84:87], v14 offset:0
  ds_read_b64_tr_b16 v[88:89], v11 offset:0
  ds_read_b64_tr_b16 v[90:91], v11 offset:512
  ds_read_b128 v[92:95], v14 offset:640
  ds_read_b64_tr_b16 v[96:97], v10 offset:4096
  ds_read_b64_tr_b16 v[98:99], v10 offset:4608
  ds_read_b128 v[100:103], v14 offset:64
  ds_read_b64_tr_b16 v[104:105], v11 offset:4096
  ds_read_b64_tr_b16 v[106:107], v11 offset:4608
  ds_read_b128 v[108:111], v14 offset:704
  s_waitcnt lgkmcnt(6)
  v_mfma_f32_16x16x32_bf16 v[64:67], v[80:83], v[84:87], 0
  v_mfma_f32_16x16x32_bf16 v[68:71], v[88:91], v[92:95], 0
  ds_read_b64_tr_b16 v[80:81], v10 offset:8192
  ds_read_b64_tr_b16 v[82:83], v10 offset:8704
  ds_read_b128 v[84:87], v14 offset:128
  ds_read_b64_tr_b16 v[88:89], v11 offset:8192
  ds_read_b64_tr_b16 v[90:91], v11 offset:8704
  ds_read_b128 v[92:95], v14 offset:768
  s_waitcnt lgkmcnt(6)
  v_mfma_f32_16x16x32_bf16 v[64:67], v[96:99], v[100:103], v[64:67]
  v_mfma_f32_16x16x32_bf16 v[68:71], v[104:107], v[108:111], v[68:71]
  ds_read_b64_tr_b16 v[96:97], v10 offset:12288
  ds_read_b64_tr_b16 v[98:99], v10 offset:12800
  ds_read_b128 v[100:103], v14 offset:192
  ds_read_b64_tr_b16 v[104:105], v11 offset:12288
  ds_read_b64_tr_b16 v[106:107], v11 offset:12800
  ds_read_b128 v[108:111], v14 offset:832
  s_waitcnt lgkmcnt(6)
  v_mfma_f32_16x16x32_bf16 v[64:67], v[80:83], v[84:87], v[64:67]
  v_mfma_f32_16x16x32_bf16 v[68:71], v[88:91], v[92:95], v[68:71]
  ds_read_b64_tr_b16 v[80:81], v10 offset:16384
  ds_read_b64_tr_b16 v[82:83], v10 offset:16896
  ds_read_b128 v[84:87], v14 offset:256
  ds_read_b64_tr_b16 v[88:89], v11 offset:16384
  ds_read_b64_tr_b16 v[90:91], v11 offset:16896
  ds_read_b128 v[92:95], v14 offset:896
  s_waitcnt lgkmcnt(6)
  v_mfma_f32_16x16x32_bf16 v[64:67], v[96:99], v[100:103], v[64:67]
  v_mfma_f32_16x16x32_bf16 v[68:71], v[104:107], v[108:111], v[68:71]
  ds_read_b64_tr_b16 v[96:97], v10 offset:20480
  ds_read_b64_tr_b16 v[98:99], v10 offset:20992
  ds_read_b128 v[100:103], v14 offset:320
  ds_read_b64_tr_b16 v[104:105], v11 offset:20480
  ds_read_b64_tr_b16 v[106:107], v11 offset:20992
  ds_read_b128 v[108:111], v14 offset:960
  s_waitcnt lgkmcnt(6)
  v_mfma_f32_16x16x32_bf16 v[64:67], v[80:83], v[84:87], v[64:67]
  v_mfma_f32_16x16x32_bf16 v[68:71], v[88:91], v[92:95], v[68:71]
  ds_read_b64_tr_b16 v[80:81], v10 offset:24576
  ds_read_b64_tr_b16 v[82:83], v10 offset:25088
  ds_read_b128 v[84:87], v14 offset:384
  ds_read_b64_tr_b16 v[88:89], v11 offset:24576
  ds_read_b64_tr_b16 v[90:91], v11 offset:25088
  ds_read_b128 v[92:95], v14 offset:1024
  s_waitcnt lgkmcnt(6)
  v_mfma_f32_16x16x32_bf16 v[64:67], v[96:99], v[100:103], v[64:67]
  v_mfma_f32_16x16x32_bf16 v[68:71], v[104:107], v[108:111], v[68:71]
  ds_read_b64_tr_b16 v[96:97], v10 offset:28672
  ds_read_b64_tr_b16 v[98:99], v10 offset:29184
  ds_read_b128 v[100:103], v14 offset:448
  ds_read_b64_tr_b16 v[104:105], v11 offset:28672
  ds_read_b64_tr_b16 v[106:107], v11 offset:29184
  ds_read_b128 v[108:111], v14 offset:1088
  s_waitcnt lgkmcnt(6)
  v_mfma_f32_16x16x32_bf16 v[64:67], v[80:83], v[84:87], v[64:67]
  v_mfma_f32_16x16x32_bf16 v[68:71], v[88:91], v[92:95], v[68:71]
  ds_read_b64_tr_b16 v[80:81], v10 offset:32768
  ds_read_b64_tr_b16 v[82:83], v10 offset:33280
  ds_read_b128 v[84:87], v14 offset:512
  ds_read_b64_tr_b16 v[88:89], v11 offset:32768
  ds_read_b64_tr_b16 v[90:91], v11 offset:33280
  ds_read_b128 v[92:95], v14 offset:1152
  s_waitcnt lgkmcnt(6)
  v_mfma_f32_16x16x32_bf16 v[64:67], v[96:99], v[100:103], v[64:67]
  v_mfma_f32_16x16x32_bf16 v[68:71], v[104:107], v[108:111], v[68:71]
  ds_read_b64_tr_b16 v[96:97], v10 offset:36864
  ds_read_b64_tr_b16 v[98:99], v10 offset:37376
  ds_read_b128 v[100:103], v14 offset:576
  ds_read_b64_tr_b16 v[104:105], v11 offset:36864
  ds_read_b64_tr_b16 v[106:107], v11 offset:37376
  ds_read_b128 v[108:111], v14 offset:1216
  s_waitcnt lgkmcnt(6)
  v_mfma_f32_16x16x32_bf16 v[64:67], v[80:83], v[84:87], v[64:67]
  v_mfma_f32_16x16x32_bf16 v[68:71], v[88:91], v[92:95], v[68:71]
  s_waitcnt lgkmcnt(0)
  v_mfma_f32_16x16x32_bf16 v[64:67], v[96:99], v[100:103], v[64:67]
  v_mfma_f32_16x16x32_bf16 v[68:71], v[104:107], v[108:111], v[68:71]
  s_nop 7
  v_add_f32 v64, v64, v68
  v_add_f32 v65, v65, v69
  v_add_f32 v66, v66, v70
  v_add_f32 v67, v67, v71
  v_cvt_pk_bf16_f32 v64, v64, v65
  v_cvt_pk_bf16_f32 v65, v66, v67
  v_min_u32 v64, -2, v64
  v_min_u32 v65, -2, v65
  v_and_b32 v6, 3, v5
  v_mul_u32_u24 v6, 7680, v6
  v_lshrrev_b32 v7, 4, v5
  v_lshl_add_u32 v6, v7, 3, v6
  s_lshl_b32 s45, s81, 7
  s_lshl_b32 s47, s44, 5
  s_add_u32 s47, s47, s45
  s_mov_b32 exec_lo, 0xf000f
  s_mov_b32 exec_hi, 0xf000f
  buffer_store_dwordx2 v[64:65], v6, s[40:43], s47 offen sc1
  s_mov_b64 exec, -1
L_h_go:
  s_nop 1
  s_cmp_lg_u32 s44, 0
  s_cbranch_scc1 L_go_skip
  s_lshl_b32 s45, s2, 7
  s_add_u32 s46, s45, 229440
  v_mov_b32 v6, 0
  s_mov_b32 s62, 0
  s_mov_b64 exec, 1
L_go1:
  buffer_load_dword v7, v6, s[40:43], s46 offen sc1
  s_add_u32 s62, s62, 1
  s_waitcnt vmcnt(0)
  v_readfirstlane_b32 s90, v7
  s_sub_u32 s45, s90, 1
  s_cmp_le_u32 s45, 1
  s_cbranch_scc1 L_go1_ok
  s_cmp_lt_u32 s62, 65536
  s_cbranch_scc1 L_go1
L_go1_ok:
  s_mov_b64 exec, -1
L_go_skip:
  s_barrier
  s_branch L_h_q
L_qrest:
  s_nop 1
  s_lshl_b32 s45, s44, 2
  s_add_u32 s45, s45, 17664
  v_mov_b32 v6, s45
  v_mov_b32 v7, 0
  ds_write_b32 v6, v7
  s_mov_b32 s40, s30
  s_mov_b32 s41, s31
  s_mov_b32 s42, 2097152
  s_mov_b32 s43, 0x20000
  s_waitcnt vmcnt(11)
  v_lshlrev_b32 v40, 16, v35
  v_and_b32 v41, 0xffff0000, v35
  v_lshlrev_b32 v42, 16, v36
  v_and_b32 v43, 0xffff0000, v36
  v_lshlrev_b32 v44, 16, v37
  v_and_b32 v45, 0xffff0000, v37
  v_lshlrev_b32 v46, 16, v38
  v_and_b32 v47, 0xffff0000, v38
  v_lshlrev_b32 v48, 16, v39
  v_and_b32 v49, 0xffff0000, v39
  v_add_f32 v6, v40, v41
  v_add_f32 v6, v6, v42
  v_add_f32 v6, v6, v43
  v_add_f32 v6, v6, v44
  v_add_f32 v6, v6, v45
  v_add_f32 v6, v6, v46
  v_add_f32 v6, v6, v47
  v_add_f32 v6, v6, v48
  v_add_f32 v6, v6, v49
  s_nop 1
  v_add_f32_dpp v6, v6, v6 row_ror:8 row_mask:0xf bank_mask:0xf
  s_nop 1
  v_add_f32_dpp v6, v6, v6 row_ror:4 row_mask:0xf bank_mask:0xf
  s_nop 1
  v_add_f32_dpp v6, v6, v6 row_ror:2 row_mask:0xf bank_mask:0xf
  s_nop 1
  v_add_f32_dpp v6, v6, v6 row_ror:1 row_mask:0xf bank_mask:0xf
  s_nop 1
  v_add_f32_dpp v6, v6, v6 row_bcast:15 row_mask:0xa bank_mask:0xf
  s_nop 1
  v_add_f32_dpp v6, v6, v6 row_bcast:31 row_mask:0xc bank_mask:0xf
  s_nop 0
  v_readlane_b32 s46, v6, 63
  v_mov_b32 v6, 0x3acccccd
  s_nop 0
  v_mul_f32 v50, s46, v6
  v_mov_b32 v7, 0
  v_sub_f32 v51, v40, v50
  v_fmac_f32 v7, v51, v51
  v_sub_f32 v51, v41, v50
  v_fmac_f32 v7, v51, v51
  v_sub_f32 v51, v42, v50
  v_fmac_f32 v7, v51, v51
  v_sub_f32 v51, v43, v50
  v_fmac_f32 v7, v51, v51
  v_sub_f32 v51, v44, v50
  v_fmac_f32 v7, v51, v51
  v_sub_f32 v51, v45, v50
  v_fmac_f32 v7, v51, v51
  v_sub_f32 v51, v46, v50
  v_fmac_f32 v7, v51, v51
  v_sub_f32 v51, v47, v50
  v_fmac_f32 v7, v51, v51
  v_sub_f32 v51, v48, v50
  v_fmac_f32 v7, v51, v51
  v_sub_f32 v51, v49, v50
  v_fmac_f32 v7, v51, v51
  s_nop 1
  v_add_f32_dpp v7, v7, v7 row_ror:8 row_mask:0xf bank_mask:0xf
  s_nop 1
  v_add_f32_dpp v7, v7, v7 row_ror:4 row_mask:0xf bank_mask:0xf
  s_nop 1
  v_add_f32_dpp v7, v7, v7 row_ror:2 row_mask:0xf bank_mask:0xf
  s_nop 1
  v_add_f32_dpp v7, v7, v7 row_ror:1 row_mask:0xf bank_mask:0xf
  s_nop 1
  v_add_f32_dpp v7, v7, v7 row_bcast:15 row_mask:0xa bank_mask:0xf
  s_nop 1
  v_add_f32_dpp v7, v7, v7 row_bcast:31 row_mask:0xc bank_mask:0xf
  s_nop 0
  v_readlane_b32 s46, v7, 63
  s_nop 1
  v_mul_f32 v52, s46, v6
  v_cvt_pk_bf16_f32 v53, v52, v52
  v_lshlrev_b32 v52, 16, v53
  v_add_f32 v52, 0x3727c5ac, v52
  v_cvt_pk_bf16_f32 v53, v52, v52
  v_lshlrev_b32 v52, 16, v53
  v_sqrt_f32 v53, v52
  v_rcp_f32 v54, v53
  v_fma_f32 v55, -v53, v53, v52
  v_mul_f32 v54, 0.5, v54
  v_fma_f32 v53, v55, v54, v53
  v_cvt_pk_bf16_f32 v53, v53, v53
  v_lshlrev_b32 v52, 16, v53
  v_cvt_pk_bf16_f32 v50, v50, v50
  v_lshlrev_b32 v50, 16, v50
  s_lshl_b32 s45, s44, 3
  s_add_u32 s45, s45, 17728
  v_mov_b32 v6, s45
  ds_write_b32 v6, v50
  ds_write_b32 v6, v52 offset:4
  s_waitcnt vmcnt(0) lgkmcnt(0)
  s_barrier
  v_lshlrev_b32 v6, 3, v17
  ds_read_b64 v[56:57], v6 offset:17728
  v_lshlrev_b32 v60, 16, v28
  v_and_b32 v61, 0xffff0000, v28
  v_lshlrev_b32 v62, 16, v29
  v_and_b32 v63, 0xffff0000, v29
  v_lshlrev_b32 v64, 16, v30
  v_and_b32 v65, 0xffff0000, v30
  v_lshlrev_b32 v66, 16, v31
  v_and_b32 v67, 0xffff0000, v31
  v_mul_u32_u24 v40, 7680, v17
  v_lshl_add_u32 v40, v18, 4, v40
  s_mul_i32 s47, s44, 160
  s_add_u32 s47, s47, 0
  v_mul_u32_u24 v41, 704, v17
  v_lshl_add_u32 v41, v18, 4, v41
  v_add_u32 v41, s47, v41
  s_waitcnt lgkmcnt(0)
  v_sub_f32 v60, v60, v56
  v_sub_f32 v61, v61, v56
  v_sub_f32 v62, v62, v56
  v_sub_f32 v63, v63, v56
  v_sub_f32 v64, v64, v56
  v_sub_f32 v65, v65, v56
  v_sub_f32 v66, v66, v56
  v_sub_f32 v67, v67, v56
  v_cvt_pk_bf16_f32 v58, v60, v61
  v_lshlrev_b32 v60, 16, v58
  v_and_b32 v61, 0xffff0000, v58
  v_cvt_pk_bf16_f32 v58, v62, v63
  v_lshlrev_b32 v62, 16, v58
  v_and_b32 v63, 0xffff0000, v58
  v_cvt_pk_bf16_f32 v58, v64, v65
  v_lshlrev_b32 v64, 16, v58
  v_and_b32 v65, 0xffff0000, v58
  v_cvt_pk_bf16_f32 v58, v66, v67
  v_lshlrev_b32 v66, 16, v58
  v_and_b32 v67, 0xffff0000, v58
  v_rcp_f32 v58, v57
  s_nop 0
  v_mul_f32 v59, v60, v58
  v_fma_f32 v60, -v59, v57, v60
  v_fma_f32 v60, v60, v58, v59
  v_mul_f32 v59, v61, v58
  v_fma_f32 v61, -v59, v57, v61
  v_fma_f32 v61, v61, v58, v59
  v_mul_f32 v59, v62, v58
  v_fma_f32 v62, -v59, v57, v62
  v_fma_f32 v62, v62, v58, v59
  v_mul_f32 v59, v63, v58
  v_fma_f32 v63, -v59, v57, v63
  v_fma_f32 v63, v63, v58, v59
  v_mul_f32 v59, v64, v58
  v_fma_f32 v64, -v59, v57, v64
  v_fma_f32 v64, v64, v58, v59
  v_mul_f32 v59, v65, v58
  v_fma_f32 v65, -v59, v57, v65
  v_fma_f32 v65, v65, v58, v59
  v_mul_f32 v59, v66, v58
  v_fma_f32 v66, -v59, v57, v66
  v_fma_f32 v66, v66, v58, v59
  v_mul_f32 v59, v67, v58
  v_fma_f32 v67, -v59, v57, v67
  v_fma_f32 v67, v67, v58, v59
  v_cvt_pk_bf16_f32 v58, v60, v61
  v_lshlrev_b32 v60, 16, v58
  v_and_b32 v61, 0xffff0000, v58
  v_cvt_pk_bf16_f32 v58, v62, v63
  v_lshlrev_b32 v62, 16, v58
  v_and_b32 v63, 0xffff0000, v58
  v_cvt_pk_bf16_f32 v58, v64, v65
  v_lshlrev_b32 v64, 16, v58
  v_and_b32 v65, 0xffff0000, v58
  v_cvt_pk_bf16_f32 v58, v66, v67
  v_lshlrev_b32 v66, 16, v58
  v_and_b32 v67, 0xffff0000, v58
  v_lshrrev_b32 v6, 4, v5
  v_bfe_u32 v7, v5, 2, 2
  v_lshl_add_u32 v10, v6, 3, v7
  v_lshlrev_b32 v10, 7, v10
  v_and_b32 v6, 1, v6
  v_lshlrev_b32 v6, 6, v6
  v_bfe_u32 v7, v5, 3, 1
  v_lshlrev_b32 v7, 5, v7
  v_or3_b32 v10, v10, v6, v7
  v_and_b32 v6, 3, v5
  v_lshl_add_u32 v10, v6, 3, v10
  s_lshl_b32 s45, s44, 5
  v_xor_b32 v10, s45, v10
  v_add_u32 v10, 29184, v10
  v_and_b32 v6, 3, v5
  v_mul_u32_u24 v14, 704, v6
  v_lshrrev_b32 v6, 4, v5
  v_lshl_add_u32 v14, v6, 4, v14
  v_and_b32 v6, 15, v5
  v_cmp_gt_u32 s[50:51], 10, v6
  s_lshl_b32 s45, s2, 7
  s_add_u32 s46, s45, 229440
  v_mov_b32 v6, 0
  s_mov_b32 s62, 0
  s_mov_b64 exec, 1
L_go2:
  buffer_load_dword v7, v6, s[40:43], s46 offen sc1
  s_add_u32 s62, s62, 1
  s_waitcnt vmcnt(0)
  v_readfirstlane_b32 s90, v7
  s_sub_u32 s45, s90, 1
  s_cmp_le_u32 s45, 1
  s_cbranch_scc1 L_go2_ok
  s_cmp_lt_u32 s62, 65536
  s_cbranch_scc1 L_go2
L_go2_ok:
  s_mov_b64 exec, -1
  s_barrier
  s_add_u32 s46, s63, 0
  s_add_u32 s47, s63, 1280
  s_mov_b32 s62, 0
L_pmod:
  buffer_load_dwordx4 v[28:31], v40, s[40:43], s46 offen sc1
  buffer_load_dwordx4 v[32:35], v40, s[40:43], s47 offen sc1
  s_add_u32 s62, s62, 1
  s_waitcnt vmcnt(0)
  v_max3_u32 v6, v28, v29, v30
  v_max3_u32 v6, v6, v31, v32
  v_max3_u32 v6, v6, v33, v34
  v_max_u32 v6, v6, v35
  v_cmp_eq_u32 vcc, -1, v6
  s_cmp_eq_u64 vcc, 0
  s_cbranch_scc1 L_pmod_ok
  s_cmp_lt_u32 s62, 65536
  s_cbranch_scc1 L_pmod
L_pmod_ok:
  v_lshlrev_b32 v44, 16, v32
  v_and_b32 v45, 0xffff0000, v32
  v_lshlrev_b32 v46, 16, v33
  v_and_b32 v47, 0xffff0000, v33
  v_lshlrev_b32 v48, 16, v34
  v_and_b32 v49, 0xffff0000, v34
  v_lshlrev_b32 v50, 16, v35
  v_and_b32 v51, 0xffff0000, v35
  v_add_f32 v44, 1.0, v44
  v_add_f32 v45, 1.0, v45
  v_add_f32 v46, 1.0, v46
  v_add_f32 v47, 1.0, v47
  v_add_f32 v48, 1.0, v48
  v_add_f32 v49, 1.0, v49
  v_add_f32 v50, 1.0, v50
  v_add_f32 v51, 1.0, v51
  v_cvt_pk_bf16_f32 v6, v44, v45
  v_lshlrev_b32 v44, 16, v6
  v_and_b32 v45, 0xffff0000, v6
  v_cvt_pk_bf16_f32 v6, v46, v47
  v_lshlrev_b32 v46, 16, v6
  v_and_b32 v47, 0xffff0000, v6
  v_cvt_pk_bf16_f32 v6, v48, v49
  v_lshlrev_b32 v48, 16, v6
  v_and_b32 v49, 0xffff0000, v6
  v_cvt_pk_bf16_f32 v6, v50, v51
  v_lshlrev_b32 v50, 16, v6
  v_and_b32 v51, 0xffff0000, v6
  v_mul_f32 v60, v60, v44
  v_mul_f32 v61, v61, v45
  v_mul_f32 v62, v62, v46
  v_mul_f32 v63, v63, v47
  v_mul_f32 v64, v64, v48
  v_mul_f32 v65, v65, v49
  v_mul_f32 v66, v66, v50
  v_mul_f32 v67, v67, v51
  v_cvt_pk_bf16_f32 v6, v60, v61
  v_lshlrev_b32 v60, 16, v6
  v_and_b32 v61, 0xffff0000, v6
  v_cvt_pk_bf16_f32 v6, v62, v63
  v_lshlrev_b32 v62, 16, v6
  v_and_b32 v63, 0xffff0000, v6
  v_cvt_pk_bf16_f32 v6, v64, v65
  v_lshlrev_b32 v64, 16, v6
  v_and_b32 v65, 0xffff0000, v6
  v_cvt_pk_bf16_f32 v6, v66, v67
  v_lshlrev_b32 v66, 16, v6
  v_and_b32 v67, 0xffff0000, v6
  v_lshlrev_b32 v44, 16, v28
  v_and_b32 v45, 0xffff0000, v28
  v_lshlrev_b32 v46, 16, v29
  v_and_b32 v47, 0xffff0000, v29
  v_lshlrev_b32 v48, 16, v30
  v_and_b32 v49, 0xffff0000, v30
  v_lshlrev_b32 v50, 16, v31
  v_and_b32 v51, 0xffff0000, v31
  v_add_f32 v60, v60, v44
  v_add_f32 v61, v61, v45
  v_add_f32 v62, v62, v46
  v_add_f32 v63, v63, v47
  v_add_f32 v64, v64, v48
  v_add_f32 v65, v65, v49
  v_add_f32 v66, v66, v50
  v_add_f32 v67, v67, v51
  v_cvt_pk_bf16_f32 v44, v60, v61
  v_cvt_pk_bf16_f32 v45, v62, v63
  v_cvt_pk_bf16_f32 v46, v64, v65
  v_cvt_pk_bf16_f32 v47, v66, v67
  s_mov_b64 exec, s[50:51]
  ds_write_b128 v41, v[44:47]
  s_mov_b64 exec, -1
  s_waitcnt lgkmcnt(0)
  s_lshl_b32 s45, s44, 2
  s_add_u32 s45, s45, 17664
  v_mov_b32 v6, s45
  v_mov_b32 v16, 2
  ds_write_b32 v6, v16
  v_mov_b32 v6, 17664
  s_mov_b32 s62, 0
L_hs2:
  ds_read_b128 v[16:19], v6
  s_add_u32 s62, s62, 1
  s_waitcnt lgkmcnt(0)
  v_min3_u32 v16, v16, v17, v18
  v_min_u32 v16, v16, v19
  s_nop 0
  v_readfirstlane_b32 s45, v16
  s_cmp_ge_u32 s45, 2
  s_cbranch_scc1 L_hs2_ok
  s_cmp_lt_u32 s62, 262144
  s_cbranch_scc1 L_hs2
L_hs2_ok:
  ds_read_b64_tr_b16 v[80:81], v10 offset:0
  ds_read_b64_tr_b16 v[82:83], v10 offset:512
  ds_read_b128 v[84:87], v14 offset:0
  ds_read_b64_tr_b16 v[88:89], v10 offset:4096
  ds_read_b64_tr_b16 v[90:91], v10 offset:4608
  ds_read_b128 v[92:95], v14 offset:64
  ds_read_b64_tr_b16 v[96:97], v10 offset:8192
  ds_read_b64_tr_b16 v[98:99], v10 offset:8704
  ds_read_b128 v[100:103], v14 offset:128
  ds_read_b64_tr_b16 v[104:105], v10 offset:12288
  ds_read_b64_tr_b16 v[106:107], v10 offset:12800
  ds_read_b128 v[108:111], v14 offset:192
  s_waitcnt lgkmcnt(9)
  v_mfma_f32_16x16x32_bf16 v[64:67], v[80:83], v[84:87], 0
  ds_read_b64_tr_b16 v[80:81], v10 offset:16384
  ds_read_b64_tr_b16 v[82:83], v10 offset:16896
  ds_read_b128 v[84:87], v14 offset:256
  s_waitcnt lgkmcnt(9)
  v_mfma_f32_16x16x32_bf16 v[64:67], v[88:91], v[92:95], v[64:67]
  ds_read_b64_tr_b16 v[88:89], v10 offset:20480
  ds_read_b64_tr_b16 v[90:91], v10 offset:20992
  ds_read_b128 v[92:95], v14 offset:320
  s_waitcnt lgkmcnt(9)
  v_mfma_f32_16x16x32_bf16 v[64:67], v[96:99], v[100:103], v[64:67]
  ds_read_b64_tr_b16 v[96:97], v10 offset:24576
  ds_read_b64_tr_b16 v[98:99], v10 offset:25088
  ds_read_b128 v[100:103], v14 offset:384
  s_waitcnt lgkmcnt(9)
  v_mfma_f32_16x16x32_bf16 v[64:67], v[104:107], v[108:111], v[64:67]
  ds_read_b64_tr_b16 v[104:105], v10 offset:28672
  ds_read_b64_tr_b16 v[106:107], v10 offset:29184
  ds_read_b128 v[108:111], v14 offset:448
  s_waitcnt lgkmcnt(9)
  v_mfma_f32_16x16x32_bf16 v[64:67], v[80:83], v[84:87], v[64:67]
  ds_read_b64_tr_b16 v[80:81], v10 offset:32768
  ds_read_b64_tr_b16 v[82:83], v10 offset:33280
  ds_read_b128 v[84:87], v14 offset:512
  s_waitcnt lgkmcnt(9)
  v_mfma_f32_16x16x32_bf16 v[64:67], v[88:91], v[92:95], v[64:67]
  ds_read_b64_tr_b16 v[88:89], v10 offset:36864
  ds_read_b64_tr_b16 v[90:91], v10 offset:37376
  ds_read_b128 v[92:95], v14 offset:576
  s_waitcnt lgkmcnt(9)
  v_mfma_f32_16x16x32_bf16 v[64:67], v[96:99], v[100:103], v[64:67]
  s_waitcnt lgkmcnt(6)
  v_mfma_f32_16x16x32_bf16 v[64:67], v[104:107], v[108:111], v[64:67]
  s_waitcnt lgkmcnt(3)
  v_mfma_f32_16x16x32_bf16 v[64:67], v[80:83], v[84:87], v[64:67]
  s_waitcnt lgkmcnt(0)
  v_mfma_f32_16x16x32_bf16 v[64:67], v[88:91], v[92:95], v[64:67]
  s_nop 7
  v_min_u32 v64, -2, v64
  v_min_u32 v65, -2, v65
  v_min_u32 v66, -2, v66
  v_min_u32 v67, -2, v67
  v_and_b32 v6, 3, v5
  v_mul_u32_u24 v6, 24576, v6
  v_lshrrev_b32 v7, 4, v5
  v_lshl_add_u32 v6, v7, 4, v6
  s_mul_i32 s45, s89, 98304
  s_lshl_b32 s47, s81, 8
  s_add_u32 s47, s47, s45
  s_lshl_b32 s45, s44, 6
  s_add_u32 s47, s47, s45
  s_add_u32 s47, s47, 32768
  s_mov_b32 exec_lo, 0xf000f
  s_mov_b32 exec_hi, 0xf000f
  buffer_store_dwordx4 v[64:67], v6, s[40:43], s47 offen sc1
  s_mov_b64 exec, -1
L_h_q:
  s_nop 1
  s_and_b32 s59, s2, 1
  s_xor_b32 s45, s2, 5
  s_cmp_eq_u32 s59, 0
  s_cselect_b32 s45, s2, s45
  s_bfe_u32 s45, s45, 0x20001
  s_lshr_b32 s46, s2, 3
  s_lshr_b32 s57, s46, 3
  s_and_b32 s46, s46, 7
  s_lshl_b32 s46, s46, 2
  s_add_u32 s58, s46, s45
  s_mov_b32 s82, 0
  s_lshr_b32 s45, s2, 1
  s_mul_i32 s46, s45, 6554
  s_lshr_b32 s46, s46, 16
  s_mov_b32 s84, s46
  s_mul_i32 s47, s46, 10
  s_sub_u32 s83, s45, s47
  s_cmp_lt_u32 s45, 80
  s_cselect_b32 s82, 1, 0
  s_bitcmp1_b32 s2, 0
  s_cbranch_scc0 L_roles_done_2
  s_mov_b32 s83, s45
  s_cmp_lt_u32 s45, 48
  s_cselect_b32 s82, 2, 0
L_roles_done_2:
  s_mov_b32 s40, s30
  s_mov_b32 s41, s31
  s_mov_b32 s42, 2097152
  s_mov_b32 s43, 0x20000
  s_cmp_lg_u32 s44, 0
  s_cbranch_scc1 L_hb1
  s_cmp_eq_u32 s90, 2
  s_cbranch_scc1 L_go3_skip
  s_lshl_b32 s45, s2, 7
  s_add_u32 s46, s45, 229440
  v_mov_b32 v6, 0
  s_mov_b32 s62, 0
  s_mov_b64 exec, 1
L_go3:
  buffer_load_dword v7, v6, s[40:43], s46 offen sc1
  s_add_u32 s62, s62, 1
  s_waitcnt vmcnt(0)
  v_readfirstlane_b32 s90, v7
  s_sub_u32 s45, s90, 2
  s_cmp_le_u32 s45, 0
  s_cbranch_scc1 L_go3_ok
  s_cmp_lt_u32 s62, 65536
  s_cbranch_scc1 L_go3
L_go3_ok:
  s_mov_b64 exec, -1
L_go3_skip:
  v_and_b32 v6, 31, v5
  v_mul_u32_u24 v11, 12, v6
  v_lshlrev_b32 v6, 1, v11
  s_mul_i32 s45, s57, 24576
  s_mul_i32 s46, s58, 768
  s_add_u32 s46, s45, s46
  s_add_u32 s46, s46, 32768
  s_add_u32 s47, s46, 98304
  s_mov_b32 s62, 0
L_pq:
  buffer_load_dwordx3 v[12:14], v6, s[40:43], s46 offen sc1
  buffer_load_dwordx3 v[16:18], v6, s[40:43], s46 offen offset:12 sc1
  buffer_load_dwordx3 v[20:22], v6, s[40:43], s47 offen sc1
  buffer_load_dwordx3 v[24:26], v6, s[40:43], s47 offen offset:12 sc1
  s_add_u32 s62, s62, 1
  s_waitcnt vmcnt(0)
  v_max3_u32 v7, v12, v13, v14
  v_max3_u32 v7, v7, v16, v17
  v_max3_u32 v7, v7, v18, v20
  v_max3_u32 v7, v7, v21, v22
  v_max3_u32 v7, v7, v24, v25
  v_max_u32 v7, v7, v26
  v_cmp_eq_u32 vcc, -1, v7
  s_cmp_eq_u64 vcc, 0
  s_cbranch_scc1 L_pq_ok
  s_cmp_lt_u32 s62, 65536
  s_cbranch_scc1 L_pq
L_pq_ok:
  v_add_f32 v12, v12, v20
  v_add_f32 v16, v16, v24
  v_add_f32 v13, v13, v21
  v_add_f32 v17, v17, v25
  v_add_f32 v14, v14, v22
  v_add_f32 v18, v18, v26
  v_cvt_pk_bf16_f32 v8, v12, v13
  v_cvt_pk_bf16_f32 v9, v14, v16
  v_cvt_pk_bf16_f32 v10, v17, v18
  ds_write_b32 v11, v8 offset:16896
  ds_write_b32 v11, v9 offset:16900
  ds_write_b32 v11, v10 offset:16904
  s_waitcnt lgkmcnt(0)
L_hb1:
  s_barrier
  s_cmp_eq_u32 s44, 0
  s_cbranch_scc1 L_late_done
  s_mov_b64 exec, 0
  s_cmp_eq_u32 s44, 1
  s_cbranch_scc1 L_hopA_0
  s_cmp_eq_u32 s44, 2
  s_cbranch_scc1 L_hopB_0
  s_branch L_hopC_0
L_warm_ret:
  s_mov_b64 exec, -1
L_late_done:
  s_nop 1
  s_barrier
  s_cmp_lg_u32 s44, 0
  s_cbranch_scc1 L_hb3
  v_and_b32 v6, 7, v5
  v_lshlrev_b32 v6, 3, v6
  ds_read_b64 v[8:9], v6 offset:17408
  s_mov_b32 s54, 0x3fb8aa3b
  s_waitcnt lgkmcnt(0)
  v_mov_b32 v10, v8
  s_nop 1
  v_max_f32_dpp v10, v10, v10 quad_perm:[1,0,3,2] row_mask:0xf bank_mask:0xf
  s_nop 1
  v_max_f32_dpp v10, v10, v10 quad_perm:[2,3,0,1] row_mask:0xf bank_mask:0xf
  s_nop 1
  v_max_f32_dpp v10, v10, v10 row_half_mirror row_mask:0xf bank_mask:0xf
  v_sub_f32 v11, v8, v10
  v_mul_f32 v11, s54, v11
  v_exp_f32 v11, v11
  s_nop 0
  v_mul_f32 v11, v11, v9
  s_nop 1
  v_add_f32_dpp v11, v11, v11 quad_perm:[1,0,3,2] row_mask:0xf bank_mask:0xf
  s_nop 1
  v_add_f32_dpp v11, v11, v11 quad_perm:[2,3,0,1] row_mask:0xf bank_mask:0xf
  s_nop 1
  v_add_f32_dpp v11, v11, v11 row_half_mirror row_mask:0xf bank_mask:0xf
  v_min_u32 v10, -2, v10
  v_min_u32 v11, -2, v11
  s_lshl_b32 s45, s2, 7
  s_add_u32 s45, s45, 229376
  v_mov_b32 v6, 0
  s_mov_b64 exec, 1
  buffer_store_dwordx2 v[10:11], v6, s[40:43], s45 offen sc1
  s_mov_b64 exec, -1
  s_xor_b32 s46, s2, 5
  s_lshl_b32 s46, s46, 7
  s_add_u32 s46, s46, 229376
  s_mov_b32 s62, 0
L_pml:
  buffer_load_dwordx2 v[12:13], v6, s[40:43], s46 offen sc1
  s_add_u32 s62, s62, 1
  s_waitcnt vmcnt(0)
  v_max_u32 v7, v12, v13
  v_cmp_eq_u32 vcc, -1, v7
  s_cmp_eq_u64 vcc, 0
  s_cbranch_scc1 L_pml_ok
  s_cmp_lt_u32 s62, 65536
  s_cbranch_scc1 L_pml
L_pml_ok:
  v_max_f32 v14, v10, v12
  v_sub_f32 v15, v10, v14
  v_sub_f32 v16, v12, v14
  v_mul_f32 v15, s54, v15
  v_mul_f32 v16, s54, v16
  v_exp_f32 v15, v15
  v_exp_f32 v16, v16
  v_mul_f32 v15, v15, v11
  v_mul_f32 v16, v16, v13
  v_add_f32 v15, v15, v16
  v_rcp_f32 v16, v15
  s_nop 0
  v_fma_f32 v17, -v15, v16, 1.0
  v_fma_f32 v16, v17, v16, v16
  v_mov_b32 v6, 17536
  ds_write_b32 v6, v14
  ds_write_b32 v6, v16 offset:4
  v_mov_b32 v17, 0
  ds_write_b32 v6, v17 offset:12
  ds_write_b32 v6, v17 offset:16
  v_mov_b32 v17, -1
  ds_write_b32 v6, v17 offset:8
  s_waitcnt lgkmcnt(0)
L_hb3:
  s_barrier
  s_cmp_lg_u32 s44, 0
  s_cbranch_scc1 L_tk_done
  v_mov_b32 v6, 17536
  s_mov_b32 s62, 0
L_tk_wait:
  ds_read_b32 v7, v6 offset:12
  s_add_u32 s62, s62, 1
  s_waitcnt lgkmcnt(0)
  v_readfirstlane_b32 s45, v7
  s_cmp_eq_u32 s45, 1
  s_cbranch_scc1 L_tk_go
  s_cmp_lt_u32 s62, 1048576
  s_cbranch_scc1 L_tk_wait
L_tk_go:
  s_mov_b64 exec, 1
  v_mov_b32 v7, 8
  v_mov_b32 v8, 1
  global_atomic_add v9, v7, v8, s[28:29] sc0 sc1
  s_waitcnt vmcnt(0)
  ds_write_b32 v6, v9 offset:8
  s_waitcnt lgkmcnt(0)
  s_mov_b64 exec, -1
L_tk_done:
  s_nop 1
  s_barrier
  s_branch L_post
L_stream_main:
  s_nop 1
  v_and_b32 v5, 63, v0
  s_mul_i32 s45, s44, 768
  v_mul_u32_u24 v1, 12, v5
  v_add_u32 v1, s45, v1
  s_mov_b32 s46, 0
  s_barrier
  buffer_load_dwordx3 v[8:10], v1, s[32:35], s46 offen nt
  s_addk_i32 s46, 6144
  buffer_load_dwordx3 v[12:14], v1, s[32:35], s46 offen nt
  s_addk_i32 s46, 6144
  s_cmp_eq_u32 s2, 0
  s_cbranch_scc0 L_nobm
  s_barrier
L_nobm:
  buffer_load_dwordx3 v[16:18], v1, s[32:35], s46 offen nt
  s_addk_i32 s46, 6144
  buffer_load_dwordx3 v[20:22], v1, s[32:35], s46 offen nt
  s_addk_i32 s46, 6144
  buffer_load_dwordx3 v[24:26], v1, s[32:35], s46 offen nt
  s_addk_i32 s46, 6144
  s_waitcnt vmcnt(4)
  buffer_load_dwordx3 v[28:30], v1, s[32:35], s46 offen nt
  s_addk_i32 s46, 6144
  s_waitcnt vmcnt(4)
  buffer_load_dwordx3 v[32:34], v1, s[32:35], s46 offen nt
  s_addk_i32 s46, 6144
  s_waitcnt vmcnt(4)
  buffer_load_dwordx3 v[36:38], v1, s[32:35], s46 offen nt
  s_addk_i32 s46, 6144
  s_waitcnt vmcnt(4)
  buffer_load_dwordx3 v[40:42], v1, s[32:35], s46 offen nt
  s_addk_i32 s46, 6144
  s_waitcnt vmcnt(4)
  buffer_load_dwordx3 v[44:46], v1, s[32:35], s46 offen nt
  s_addk_i32 s46, 6144
  s_waitcnt vmcnt(4)
  buffer_load_dwordx3 v[48:50], v1, s[32:35], s46 offen nt
  s_addk_i32 s46, 6144
  s_waitcnt vmcnt(4)
  buffer_load_dwordx3 v[52:54], v1, s[32:35], s46 offen nt
  s_addk_i32 s46, 6144
  s_waitcnt vmcnt(4)
  buffer_load_dwordx3 v[56:58], v1, s[32:35], s46 offen nt
  s_addk_i32 s46, 6144
  s_waitcnt vmcnt(4)
  buffer_load_dwordx3 v[60:62], v1, s[32:35], s46 offen nt
  s_addk_i32 s46, 6144
  s_waitcnt vmcnt(4)
  buffer_load_dwordx3 v[64:66], v1, s[32:35], s46 offen nt
  s_addk_i32 s46, 6144
  s_waitcnt vmcnt(4)
  buffer_load_dwordx3 v[68:70], v1, s[32:35], s46 offen nt
  s_addk_i32 s46, 6144
  s_barrier
  s_waitcnt vmcnt(4)
  buffer_load_dwordx3 v[72:74], v1, s[32:35], s46 offen nt
  s_addk_i32 s46, 6144
  s_waitcnt vmcnt(4)
  buffer_load_dwordx3 v[76:78], v1, s[32:35], s46 offen nt
  s_addk_i32 s46, 6144
  s_waitcnt vmcnt(4)
  buffer_load_dwordx3 v[80:82], v1, s[32:35], s46 offen nt
  s_addk_i32 s46, 6144
  s_waitcnt vmcnt(4)
  buffer_load_dwordx3 v[84:86], v1, s[32:35], s46 offen nt
  s_addk_i32 s46, 6144
  s_waitcnt vmcnt(4)
  buffer_load_dwordx3 v[88:90], v1, s[32:35], s46 offen nt
  s_addk_i32 s46, 6144
  s_waitcnt vmcnt(4)
  buffer_load_dwordx3 v[92:94], v1, s[32:35], s46 offen nt
  s_addk_i32 s46, 6144
  s_waitcnt vmcnt(4)
  buffer_load_dwordx3 v[96:98], v1, s[32:35], s46 offen nt
  s_addk_i32 s46, 6144
  s_waitcnt vmcnt(4)
  buffer_load_dwordx3 v[100:102], v1, s[32:35], s46 offen nt
  s_addk_i32 s46, 6144
  s_waitcnt vmcnt(4)
  buffer_load_dwordx3 v[104:106], v1, s[32:35], s46 offen nt
  s_addk_i32 s46, 6144
  s_waitcnt vmcnt(4)
  buffer_load_dwordx3 v[108:110], v1, s[32:35], s46 offen nt
  s_addk_i32 s46, 6144
  s_waitcnt vmcnt(4)
  buffer_load_dwordx3 v[112:114], v1, s[32:35], s46 offen nt
  s_addk_i32 s46, 6144
  s_waitcnt vmcnt(4)
  buffer_load_dwordx3 v[116:118], v1, s[32:35], s46 offen nt
  s_addk_i32 s46, 6144
  s_waitcnt vmcnt(4)
  buffer_load_dwordx3 v[120:122], v1, s[32:35], s46 offen nt
  s_addk_i32 s46, 6144
  s_waitcnt vmcnt(4)
  buffer_load_dwordx3 v[124:126], v1, s[32:35], s46 offen nt
  s_addk_i32 s46, 6144
  s_waitcnt vmcnt(4)
  buffer_load_dwordx3 v[128:130], v1, s[32:35], s46 offen nt
  s_addk_i32 s46, 6144
  s_waitcnt vmcnt(4)
  buffer_load_dwordx3 v[132:134], v1, s[32:35], s46 offen nt
  s_addk_i32 s46, 6144
  s_mov_b32 s48, 0xaaaaaaaa
  s_mov_b32 s49, 0xaaaaaaaa
  s_mov_b32 s50, 0xcccccccc
  s_mov_b32 s51, 0xcccccccc
  s_mov_b32 s52, 0x05040100
  s_mov_b32 s53, 0x07060302
  s_mov_b32 s54, 0x3fb8aa3b
  v_and_b32 v6, 31, v5
  v_mul_u32_u24 v6, 12, v6
  v_lshrrev_b32 v7, 5, v5
  v_mul_u32_u24 v67, 320, v7
  s_mul_i32 s45, s44, 640
  s_add_u32 s45, s45, 17920
  v_add_u32 v67, s45, v67
  v_bfe_u32 v75, v5, 4, 1
  v_lshl_add_u32 v71, v75, 1, v67
  v_bfe_u32 v75, v5, 3, 1
  v_lshl_add_u32 v71, v75, 2, v71
  v_bfe_u32 v75, v5, 2, 1
  v_lshl_add_u32 v71, v75, 3, v71
  v_bfe_u32 v75, v5, 0, 1
  v_lshl_add_u32 v71, v75, 4, v71
  v_bfe_u32 v75, v5, 1, 1
  v_lshl_add_u32 v71, v75, 5, v71
  v_bfe_u32 v157, v5, 4, 1
  v_bfe_u32 v75, v5, 3, 1
  v_lshl_or_b32 v157, v75, 1, v157
  v_bfe_u32 v75, v5, 2, 1
  v_lshl_or_b32 v157, v75, 2, v157
  v_bfe_u32 v75, v5, 0, 1
  v_lshl_or_b32 v157, v75, 3, v157
  v_bfe_u32 v75, v5, 1, 1
  v_lshl_or_b32 v157, v75, 4, v157
  v_mov_b32 v115, 0
  v_mov_b32 v119, 0
  v_mov_b32 v123, 0
  v_mov_b32 v127, 0
  v_mov_b32 v131, 0
  v_mov_b32 v135, 0
  s_barrier
  ds_read_b32 v2, v6 offset:16896
  ds_read_b32 v3, v6 offset:16900
  ds_read_b32 v4, v6 offset:16904
  s_waitcnt lgkmcnt(0)
  v_dot2_f32_bf16 v11, v8, v2, 0
  v_dot2_f32_bf16 v11, v9, v3, v11
  v_dot2_f32_bf16 v11, v10, v4, v11
  buffer_load_dwordx3 v[8:10], v1, s[32:35], s46 offen nt
  s_addk_i32 s46, 6144
  v_dot2_f32_bf16 v15, v12, v2, 0
  v_dot2_f32_bf16 v15, v13, v3, v15
  v_dot2_f32_bf16 v15, v14, v4, v15
  buffer_load_dwordx3 v[12:14], v1, s[32:35], s46 offen nt
  s_addk_i32 s46, 6144
  s_nop 0
  v_permlane16_swap_b32 v11, v15
  v_add_f32 v19, v11, v15
  v_dot2_f32_bf16 v11, v16, v2, 0
  v_dot2_f32_bf16 v11, v17, v3, v11
  v_dot2_f32_bf16 v11, v18, v4, v11
  buffer_load_dwordx3 v[16:18], v1, s[32:35], s46 offen nt
  s_addk_i32 s46, 6144
  v_dot2_f32_bf16 v15, v20, v2, 0
  v_dot2_f32_bf16 v15, v21, v3, v15
  v_dot2_f32_bf16 v15, v22, v4, v15
  buffer_load_dwordx3 v[20:22], v1, s[32:35], s46 offen nt
  s_addk_i32 s46, 6144
  s_nop 0
  v_permlane16_swap_b32 v11, v15
  v_add_f32 v23, v11, v15
  v_add_f32_dpp v27, v19, v19 row_ror:8 row_mask:0xf bank_mask:0x3
  s_nop 0
  v_add_f32_dpp v27, v23, v23 row_ror:8 row_mask:0xf bank_mask:0xc
  v_dot2_f32_bf16 v11, v24, v2, 0
  v_dot2_f32_bf16 v11, v25, v3, v11
  v_dot2_f32_bf16 v11, v26, v4, v11
  buffer_load_dwordx3 v[24:26], v1, s[32:35], s46 offen nt
  s_addk_i32 s46, 6144
  v_dot2_f32_bf16 v15, v28, v2, 0
  v_dot2_f32_bf16 v15, v29, v3, v15
  v_dot2_f32_bf16 v15, v30, v4, v15
  buffer_load_dwordx3 v[28:30], v1, s[32:35], s46 offen nt
  s_addk_i32 s46, 6144
  s_nop 0
  v_permlane16_swap_b32 v11, v15
  v_add_f32 v19, v11, v15
  v_dot2_f32_bf16 v11, v32, v2, 0
  v_dot2_f32_bf16 v11, v33, v3, v11
  v_dot2_f32_bf16 v11, v34, v4, v11
  buffer_load_dwordx3 v[32:34], v1, s[32:35], s46 offen nt
  s_addk_i32 s46, 6144
  v_dot2_f32_bf16 v15, v36, v2, 0
  v_dot2_f32_bf16 v15, v37, v3, v15
  v_dot2_f32_bf16 v15, v38, v4, v15
  buffer_load_dwordx3 v[36:38], v1, s[32:35], s46 offen nt
  s_addk_i32 s46, 6144
  s_nop 0
  v_permlane16_swap_b32 v11, v15
  v_add_f32 v23, v11, v15
  v_add_f32_dpp v31, v19, v19 row_ror:8 row_mask:0xf bank_mask:0x3
  s_nop 0
  v_add_f32_dpp v31, v23, v23 row_ror:8 row_mask:0xf bank_mask:0xc
  v_add_f32_dpp v35, v27, v27 row_half_mirror row_mask:0xf bank_mask:0x5
  s_nop 0
  v_add_f32_dpp v35, v31, v31 row_half_mirror row_mask:0xf bank_mask:0xa
  v_dot2_f32_bf16 v11, v40, v2, 0
  v_dot2_f32_bf16 v11, v41, v3, v11
  v_dot2_f32_bf16 v11, v42, v4, v11
  buffer_load_dwordx3 v[40:42], v1, s[32:35], s46 offen nt
  s_addk_i32 s46, 6144
  v_dot2_f32_bf16 v15, v44, v2, 0
  v_dot2_f32_bf16 v15, v45, v3, v15
  v_dot2_f32_bf16 v15, v46, v4, v15
  buffer_load_dwordx3 v[44:46], v1, s[32:35], s46 offen nt
  s_addk_i32 s46, 6144
  s_nop 0
  v_permlane16_swap_b32 v11, v15
  v_add_f32 v19, v11, v15
  v_dot2_f32_bf16 v11, v48, v2, 0
  v_dot2_f32_bf16 v11, v49, v3, v11
  v_dot2_f32_bf16 v11, v50, v4, v11
  buffer_load_dwordx3 v[48:50], v1, s[32:35], s46 offen nt
  s_addk_i32 s46, 6144
  v_dot2_f32_bf16 v15, v52, v2, 0
  v_dot2_f32_bf16 v15, v53, v3, v15
  v_dot2_f32_bf16 v15, v54, v4, v15
  buffer_load_dwordx3 v[52:54], v1, s[32:35], s46 offen nt
  s_addk_i32 s46, 6144
  s_nop 0
  v_permlane16_swap_b32 v11, v15
  v_add_f32 v23, v11, v15
  v_add_f32_dpp v27, v19, v19 row_ror:8 row_mask:0xf bank_mask:0x3
  s_nop 0
  v_add_f32_dpp v27, v23, v23 row_ror:8 row_mask:0xf bank_mask:0xc
  v_dot2_f32_bf16 v11, v56, v2, 0
  v_dot2_f32_bf16 v11, v57, v3, v11
  v_dot2_f32_bf16 v11, v58, v4, v11
  buffer_load_dwordx3 v[56:58], v1, s[32:35], s46 offen nt
  s_addk_i32 s46, 6144
  v_dot2_f32_bf16 v15, v60, v2, 0
  v_dot2_f32_bf16 v15, v61, v3, v15
  v_dot2_f32_bf16 v15, v62, v4, v15
  buffer_load_dwordx3 v[60:62], v1, s[32:35], s46 offen nt
  s_addk_i32 s46, 6144
  s_nop 0
  v_permlane16_swap_b32 v11, v15
  v_add_f32 v19, v11, v15
  v_dot2_f32_bf16 v11, v64, v2, 0
  v_dot2_f32_bf16 v11, v65, v3, v11
  v_dot2_f32_bf16 v11, v66, v4, v11
  buffer_load_dwordx3 v[64:66], v1, s[32:35], s46 offen nt
  s_addk_i32 s46, 6144
  v_dot2_f32_bf16 v15, v68, v2, 0
  v_dot2_f32_bf16 v15, v69, v3, v15
  v_dot2_f32_bf16 v15, v70, v4, v15
  buffer_load_dwordx3 v[68:70], v1, s[32:35], s46 offen nt
  s_addk_i32 s46, 6144
  s_nop 0
  v_permlane16_swap_b32 v11, v15
  v_add_f32 v23, v11, v15
  v_add_f32_dpp v31, v19, v19 row_ror:8 row_mask:0xf bank_mask:0x3
  s_nop 0
  v_add_f32_dpp v31, v23, v23 row_ror:8 row_mask:0xf bank_mask:0xc
  v_add_f32_dpp v39, v27, v27 row_half_mirror row_mask:0xf bank_mask:0x5
  s_nop 0
  v_add_f32_dpp v39, v31, v31 row_half_mirror row_mask:0xf bank_mask:0xa
  v_add_f32_dpp v59, v35, v35 quad_perm:[1,0,3,2] row_mask:0xf bank_mask:0xf
  s_nop 0
  v_add_f32_dpp v63, v39, v39 quad_perm:[1,0,3,2] row_mask:0xf bank_mask:0xf
  v_cndmask_b32 v51, v59, v63, s[48:49]
  v_dot2_f32_bf16 v11, v72, v2, 0
  v_dot2_f32_bf16 v11, v73, v3, v11
  v_dot2_f32_bf16 v11, v74, v4, v11
  buffer_load_dwordx3 v[72:74], v1, s[32:35], s46 offen nt
  s_addk_i32 s46, 6144
  v_dot2_f32_bf16 v15, v76, v2, 0
  v_dot2_f32_bf16 v15, v77, v3, v15
  v_dot2_f32_bf16 v15, v78, v4, v15
  buffer_load_dwordx3 v[76:78], v1, s[32:35], s46 offen nt
  s_addk_i32 s46, 6144
  s_nop 0
  v_permlane16_swap_b32 v11, v15
  v_add_f32 v19, v11, v15
  v_dot2_f32_bf16 v11, v80, v2, 0
  v_dot2_f32_bf16 v11, v81, v3, v11
  v_dot2_f32_bf16 v11, v82, v4, v11
  buffer_load_dwordx3 v[80:82], v1, s[32:35], s46 offen nt
  s_addk_i32 s46, 6144
  v_dot2_f32_bf16 v15, v84, v2, 0
  v_dot2_f32_bf16 v15, v85, v3, v15
  v_dot2_f32_bf16 v15, v86, v4, v15
  buffer_load_dwordx3 v[84:86], v1, s[32:35], s46 offen nt
  s_addk_i32 s46, 6144
  s_nop 0
  v_permlane16_swap_b32 v11, v15
  v_add_f32 v23, v11, v15
  v_add_f32_dpp v27, v19, v19 row_ror:8 row_mask:0xf bank_mask:0x3
  s_nop 0
  v_add_f32_dpp v27, v23, v23 row_ror:8 row_mask:0xf bank_mask:0xc
  v_dot2_f32_bf16 v11, v88, v2, 0
  v_dot2_f32_bf16 v11, v89, v3, v11
  v_dot2_f32_bf16 v11, v90, v4, v11
  buffer_load_dwordx3 v[88:90], v1, s[32:35], s46 offen nt
  s_addk_i32 s46, 6144
  v_dot2_f32_bf16 v15, v92, v2, 0
  v_dot2_f32_bf16 v15, v93, v3, v15
  v_dot2_f32_bf16 v15, v94, v4, v15
  buffer_load_dwordx3 v[92:94], v1, s[32:35], s46 offen nt
  s_addk_i32 s46, 6144
  s_nop 0
  v_permlane16_swap_b32 v11, v15
  v_add_f32 v19, v11, v15
  v_dot2_f32_bf16 v11, v96, v2, 0
  v_dot2_f32_bf16 v11, v97, v3, v11
  v_dot2_f32_bf16 v11, v98, v4, v11
  buffer_load_dwordx3 v[96:98], v1, s[32:35], s46 offen nt
  s_addk_i32 s46, 6144
  v_dot2_f32_bf16 v15, v100, v2, 0
  v_dot2_f32_bf16 v15, v101, v3, v15
  v_dot2_f32_bf16 v15, v102, v4, v15
  buffer_load_dwordx3 v[100:102], v1, s[32:35], s46 offen nt
  s_addk_i32 s46, 6144
  s_nop 0
  v_permlane16_swap_b32 v11, v15
  v_add_f32 v23, v11, v15
  v_add_f32_dpp v31, v19, v19 row_ror:8 row_mask:0xf bank_mask:0x3
  s_nop 0
  v_add_f32_dpp v31, v23, v23 row_ror:8 row_mask:0xf bank_mask:0xc
  v_add_f32_dpp v43, v27, v27 row_half_mirror row_mask:0xf bank_mask:0x5
  s_nop 0
  v_add_f32_dpp v43, v31, v31 row_half_mirror row_mask:0xf bank_mask:0xa
  v_dot2_f32_bf16 v11, v104, v2, 0
  v_dot2_f32_bf16 v11, v105, v3, v11
  v_dot2_f32_bf16 v11, v106, v4, v11
  buffer_load_dwordx3 v[104:106], v1, s[32:35], s46 offen nt
  s_addk_i32 s46, 6144
  v_dot2_f32_bf16 v15, v108, v2, 0
  v_dot2_f32_bf16 v15, v109, v3, v15
  v_dot2_f32_bf16 v15, v110, v4, v15
  buffer_load_dwordx3 v[108:110], v1, s[32:35], s46 offen nt
  s_addk_i32 s46, 6144
  s_nop 0
  v_permlane16_swap_b32 v11, v15
  v_add_f32 v19, v11, v15
  v_dot2_f32_bf16 v11, v112, v2, 0
  v_dot2_f32_bf16 v11, v113, v3, v11
  v_dot2_f32_bf16 v11, v114, v4, v11
  buffer_load_dwordx3 v[112:114], v1, s[32:35], s46 offen nt
  s_addk_i32 s46, 6144
  s_waitcnt vmcnt(31)
  v_dot2_f32_bf16 v15, v116, v2, 0
  v_dot2_f32_bf16 v15, v117, v3, v15
  v_dot2_f32_bf16 v15, v118, v4, v15
  buffer_load_dwordx3 v[116:118], v1, s[32:35], s46 offen nt
  s_addk_i32 s46, 6144
  s_nop 0
  v_permlane16_swap_b32 v11, v15
  v_add_f32 v23, v11, v15
  v_add_f32_dpp v27, v19, v19 row_ror:8 row_mask:0xf bank_mask:0x3
  s_nop 0
  v_add_f32_dpp v27, v23, v23 row_ror:8 row_mask:0xf bank_mask:0xc
  s_waitcnt vmcnt(31)
  v_dot2_f32_bf16 v11, v120, v2, 0
  v_dot2_f32_bf16 v11, v121, v3, v11
  v_dot2_f32_bf16 v11, v122, v4, v11
  buffer_load_dwordx3 v[120:122], v1, s[32:35], s46 offen nt
  s_addk_i32 s46, 6144
  s_waitcnt vmcnt(31)
  v_dot2_f32_bf16 v15, v124, v2, 0
  v_dot2_f32_bf16 v15, v125, v3, v15
  v_dot2_f32_bf16 v15, v126, v4, v15
  buffer_load_dwordx3 v[124:126], v1, s[32:35], s46 offen nt
  s_addk_i32 s46, 6144
  s_nop 0
  v_permlane16_swap_b32 v11, v15
  v_add_f32 v19, v11, v15
  s_waitcnt vmcnt(31)
  v_dot2_f32_bf16 v11, v128, v2, 0
  v_dot2_f32_bf16 v11, v129, v3, v11
  v_dot2_f32_bf16 v11, v130, v4, v11
  buffer_load_dwordx3 v[128:130], v1, s[32:35], s46 offen nt
  s_addk_i32 s46, 6144
  s_waitcnt vmcnt(31)
  v_dot2_f32_bf16 v15, v132, v2, 0
  v_dot2_f32_bf16 v15, v133, v3, v15
  v_dot2_f32_bf16 v15, v134, v4, v15
  buffer_load_dwordx3 v[132:134], v1, s[32:35], s46 offen nt
  s_addk_i32 s46, 6144
  s_nop 0
  v_permlane16_swap_b32 v11, v15
  v_add_f32 v23, v11, v15
  v_add_f32_dpp v31, v19, v19 row_ror:8 row_mask:0xf bank_mask:0x3
  s_nop 0
  v_add_f32_dpp v31, v23, v23 row_ror:8 row_mask:0xf bank_mask:0xc
  v_add_f32_dpp v47, v27, v27 row_half_mirror row_mask:0xf bank_mask:0x5
  s_nop 0
  v_add_f32_dpp v47, v31, v31 row_half_mirror row_mask:0xf bank_mask:0xa
  v_add_f32_dpp v59, v43, v43 quad_perm:[1,0,3,2] row_mask:0xf bank_mask:0xf
  s_nop 0
  v_add_f32_dpp v63, v47, v47 quad_perm:[1,0,3,2] row_mask:0xf bank_mask:0xf
  v_cndmask_b32 v55, v59, v63, s[48:49]
  v_add_f32_dpp v59, v51, v51 quad_perm:[2,3,0,1] row_mask:0xf bank_mask:0xf
  s_nop 0
  v_add_f32_dpp v63, v55, v55 quad_perm:[2,3,0,1] row_mask:0xf bank_mask:0xf
  v_cndmask_b32 v99, v59, v63, s[50:51]
  s_waitcnt vmcnt(31)
  v_dot2_f32_bf16 v11, v8, v2, 0
  v_dot2_f32_bf16 v11, v9, v3, v11
  v_dot2_f32_bf16 v11, v10, v4, v11
  buffer_load_dwordx3 v[8:10], v1, s[32:35], s46 offen nt
  s_addk_i32 s46, 6144
  s_waitcnt vmcnt(31)
  v_dot2_f32_bf16 v15, v12, v2, 0
  v_dot2_f32_bf16 v15, v13, v3, v15
  v_dot2_f32_bf16 v15, v14, v4, v15
  buffer_load_dwordx3 v[12:14], v1, s[32:35], s46 offen nt
  s_addk_i32 s46, 6144
  s_nop 0
  v_permlane16_swap_b32 v11, v15
  v_add_f32 v19, v11, v15
  s_waitcnt vmcnt(31)
  v_dot2_f32_bf16 v11, v16, v2, 0
  v_dot2_f32_bf16 v11, v17, v3, v11
  v_dot2_f32_bf16 v11, v18, v4, v11
  buffer_load_dwordx3 v[16:18], v1, s[32:35], s46 offen nt
  s_addk_i32 s46, 6144
  s_waitcnt vmcnt(31)
  v_dot2_f32_bf16 v15, v20, v2, 0
  v_dot2_f32_bf16 v15, v21, v3, v15
  v_dot2_f32_bf16 v15, v22, v4, v15
  buffer_load_dwordx3 v[20:22], v1, s[32:35], s46 offen nt
  s_addk_i32 s46, 6144
  s_nop 0
  v_permlane16_swap_b32 v11, v15
  v_add_f32 v23, v11, v15
  v_add_f32_dpp v27, v19, v19 row_ror:8 row_mask:0xf bank_mask:0x3
  s_nop 0
  v_add_f32_dpp v27, v23, v23 row_ror:8 row_mask:0xf bank_mask:0xc
  s_waitcnt vmcnt(31)
  v_dot2_f32_bf16 v11, v24, v2, 0
  v_dot2_f32_bf16 v11, v25, v3, v11
  v_dot2_f32_bf16 v11, v26, v4, v11
  buffer_load_dwordx3 v[24:26], v1, s[32:35], s46 offen nt
  s_addk_i32 s46, 6144
  s_waitcnt vmcnt(31)
  v_dot2_f32_bf16 v15, v28, v2, 0
  v_dot2_f32_bf16 v15, v29, v3, v15
  v_dot2_f32_bf16 v15, v30, v4, v15
  buffer_load_dwordx3 v[28:30], v1, s[32:35], s46 offen nt
  s_addk_i32 s46, 6144
  s_nop 0
  v_permlane16_swap_b32 v11, v15
  v_add_f32 v19, v11, v15
  s_waitcnt vmcnt(31)
  v_dot2_f32_bf16 v11, v32, v2, 0
  v_dot2_f32_bf16 v11, v33, v3, v11
  v_dot2_f32_bf16 v11, v34, v4, v11
  buffer_load_dwordx3 v[32:34], v1, s[32:35], s46 offen nt
  s_addk_i32 s46, 6144
  s_waitcnt vmcnt(31)
  v_dot2_f32_bf16 v15, v36, v2, 0
  v_dot2_f32_bf16 v15, v37, v3, v15
  v_dot2_f32_bf16 v15, v38, v4, v15
  buffer_load_dwordx3 v[36:38], v1, s[32:35], s46 offen nt
  s_addk_i32 s46, 6144
  s_nop 0
  v_permlane16_swap_b32 v11, v15
  v_add_f32 v23, v11, v15
  v_add_f32_dpp v31, v19, v19 row_ror:8 row_mask:0xf bank_mask:0x3
  s_nop 0
  v_add_f32_dpp v31, v23, v23 row_ror:8 row_mask:0xf bank_mask:0xc
  v_add_f32_dpp v35, v27, v27 row_half_mirror row_mask:0xf bank_mask:0x5
  s_nop 0
  v_add_f32_dpp v35, v31, v31 row_half_mirror row_mask:0xf bank_mask:0xa
  s_waitcnt vmcnt(31)
  v_dot2_f32_bf16 v11, v40, v2, 0
  v_dot2_f32_bf16 v11, v41, v3, v11
  v_dot2_f32_bf16 v11, v42, v4, v11
  buffer_load_dwordx3 v[40:42], v1, s[32:35], s46 offen nt
  s_addk_i32 s46, 6144
  s_waitcnt vmcnt(31)
  v_dot2_f32_bf16 v15, v44, v2, 0
  v_dot2_f32_bf16 v15, v45, v3, v15
  v_dot2_f32_bf16 v15, v46, v4, v15
  buffer_load_dwordx3 v[44:46], v1, s[32:35], s46 offen nt
  s_addk_i32 s46, 6144
  s_nop 0
  v_permlane16_swap_b32 v11, v15
  v_add_f32 v19, v11, v15
  s_waitcnt vmcnt(31)
  v_dot2_f32_bf16 v11, v48, v2, 0
  v_dot2_f32_bf16 v11, v49, v3, v11
  v_dot2_f32_bf16 v11, v50, v4, v11
  buffer_load_dwordx3 v[48:50], v1, s[32:35], s46 offen nt
  s_addk_i32 s46, 6144
  s_waitcnt vmcnt(31)
  v_dot2_f32_bf16 v15, v52, v2, 0
  v_dot2_f32_bf16 v15, v53, v3, v15
  v_dot2_f32_bf16 v15, v54, v4, v15
  buffer_load_dwordx3 v[52:54], v1, s[32:35], s46 offen nt
  s_addk_i32 s46, 6144
  s_nop 0
  v_permlane16_swap_b32 v11, v15
  v_add_f32 v23, v11, v15
  v_add_f32_dpp v27, v19, v19 row_ror:8 row_mask:0xf bank_mask:0x3
  s_nop 0
  v_add_f32_dpp v27, v23, v23 row_ror:8 row_mask:0xf bank_mask:0xc
  s_waitcnt vmcnt(31)
  v_dot2_f32_bf16 v11, v56, v2, 0
  v_dot2_f32_bf16 v11, v57, v3, v11
  v_dot2_f32_bf16 v11, v58, v4, v11
  buffer_load_dwordx3 v[56:58], v1, s[32:35], s46 offen nt
  s_addk_i32 s46, 6144
  s_waitcnt vmcnt(31)
  v_dot2_f32_bf16 v15, v60, v2, 0
  v_dot2_f32_bf16 v15, v61, v3, v15
  v_dot2_f32_bf16 v15, v62, v4, v15
  buffer_load_dwordx3 v[60:62], v1, s[32:35], s46 offen nt
  s_addk_i32 s46, 6144
  s_nop 0
  v_permlane16_swap_b32 v11, v15
  v_add_f32 v19, v11, v15
  s_waitcnt vmcnt(31)
  v_dot2_f32_bf16 v11, v64, v2, 0
  v_dot2_f32_bf16 v11, v65, v3, v11
  v_dot2_f32_bf16 v11, v66, v4, v11
  buffer_load_dwordx3 v[64:66], v1, s[32:35], s46 offen nt
  s_addk_i32 s46, 6144
  s_waitcnt vmcnt(31)
  v_dot2_f32_bf16 v15, v68, v2, 0
  v_dot2_f32_bf16 v15, v69, v3, v15
  v_dot2_f32_bf16 v15, v70, v4, v15
  buffer_load_dwordx3 v[68:70], v1, s[32:35], s46 offen nt
  s_addk_i32 s46, 6144
  s_nop 0
  v_permlane16_swap_b32 v11, v15
  v_add_f32 v23, v11, v15
  v_add_f32_dpp v31, v19, v19 row_ror:8 row_mask:0xf bank_mask:0x3
  s_nop 0
  v_add_f32_dpp v31, v23, v23 row_ror:8 row_mask:0xf bank_mask:0xc
  v_add_f32_dpp v39, v27, v27 row_half_mirror row_mask:0xf bank_mask:0x5
  s_nop 0
  v_add_f32_dpp v39, v31, v31 row_half_mirror row_mask:0xf bank_mask:0xa
  v_add_f32_dpp v59, v35, v35 quad_perm:[1,0,3,2] row_mask:0xf bank_mask:0xf
  s_nop 0
  v_add_f32_dpp v63, v39, v39 quad_perm:[1,0,3,2] row_mask:0xf bank_mask:0xf
  v_cndmask_b32 v51, v59, v63, s[48:49]
  s_waitcnt vmcnt(31)
  v_dot2_f32_bf16 v11, v72, v2, 0
  v_dot2_f32_bf16 v11, v73, v3, v11
  v_dot2_f32_bf16 v11, v74, v4, v11
  buffer_load_dwordx3 v[72:74], v1, s[32:35], s46 offen nt
  s_addk_i32 s46, 6144
  s_waitcnt vmcnt(31)
  v_dot2_f32_bf16 v15, v76, v2, 0
  v_dot2_f32_bf16 v15, v77, v3, v15
  v_dot2_f32_bf16 v15, v78, v4, v15
  buffer_load_dwordx3 v[76:78], v1, s[32:35], s46 offen nt
  s_addk_i32 s46, 6144
  s_nop 0
  v_permlane16_swap_b32 v11, v15
  v_add_f32 v19, v11, v15
  s_waitcnt vmcnt(31)
  v_dot2_f32_bf16 v11, v80, v2, 0
  v_dot2_f32_bf16 v11, v81, v3, v11
  v_dot2_f32_bf16 v11, v82, v4, v11
  buffer_load_dwordx3 v[80:82], v1, s[32:35], s46 offen nt
  s_addk_i32 s46, 6144
  s_waitcnt vmcnt(31)
  v_dot2_f32_bf16 v15, v84, v2, 0
  v_dot2_f32_bf16 v15, v85, v3, v15
  v_dot2_f32_bf16 v15, v86, v4, v15
  buffer_load_dwordx3 v[84:86], v1, s[32:35], s46 offen nt
  s_addk_i32 s46, 6144
  s_nop 0
  v_permlane16_swap_b32 v11, v15
  v_add_f32 v23, v11, v15
  v_add_f32_dpp v27, v19, v19 row_ror:8 row_mask:0xf bank_mask:0x3
  s_nop 0
  v_add_f32_dpp v27, v23, v23 row_ror:8 row_mask:0xf bank_mask:0xc
  s_waitcnt vmcnt(31)
  v_dot2_f32_bf16 v11, v88, v2, 0
  v_dot2_f32_bf16 v11, v89, v3, v11
  v_dot2_f32_bf16 v11, v90, v4, v11
  buffer_load_dwordx3 v[88:90], v1, s[32:35], s46 offen nt
  s_addk_i32 s46, 6144
  s_waitcnt vmcnt(31)
  v_dot2_f32_bf16 v15, v92, v2, 0
  v_dot2_f32_bf16 v15, v93, v3, v15
  v_dot2_f32_bf16 v15, v94, v4, v15
  buffer_load_dwordx3 v[92:94], v1, s[32:35], s46 offen nt
  s_addk_i32 s46, 6144
  s_nop 0
  v_permlane16_swap_b32 v11, v15
  v_add_f32 v19, v11, v15
  s_waitcnt vmcnt(31)
  v_dot2_f32_bf16 v11, v96, v2, 0
  v_dot2_f32_bf16 v11, v97, v3, v11
  v_dot2_f32_bf16 v11, v98, v4, v11
  buffer_load_dwordx3 v[96:98], v1, s[32:35], s46 offen nt
  s_addk_i32 s46, 6144
  s_waitcnt vmcnt(31)
  v_dot2_f32_bf16 v15, v100, v2, 0
  v_dot2_f32_bf16 v15, v101, v3, v15
  v_dot2_f32_bf16 v15, v102, v4, v15
  buffer_load_dwordx3 v[100:102], v1, s[32:35], s46 offen nt
  s_addk_i32 s46, 6144
  s_nop 0
  v_permlane16_swap_b32 v11, v15
  v_add_f32 v23, v11, v15
  v_add_f32_dpp v31, v19, v19 row_ror:8 row_mask:0xf bank_mask:0x3
  s_nop 0
  v_add_f32_dpp v31, v23, v23 row_ror:8 row_mask:0xf bank_mask:0xc
  v_add_f32_dpp v43, v27, v27 row_half_mirror row_mask:0xf bank_mask:0x5
  s_nop 0
  v_add_f32_dpp v43, v31, v31 row_half_mirror row_mask:0xf bank_mask:0xa
  s_waitcnt vmcnt(31)
  v_dot2_f32_bf16 v11, v104, v2, 0
  v_dot2_f32_bf16 v11, v105, v3, v11
  v_dot2_f32_bf16 v11, v106, v4, v11
  buffer_load_dwordx3 v[104:106], v1, s[32:35], s46 offen nt
  s_addk_i32 s46, 6144
  s_waitcnt vmcnt(31)
  v_dot2_f32_bf16 v15, v108, v2, 0
  v_dot2_f32_bf16 v15, v109, v3, v15
  v_dot2_f32_bf16 v15, v110, v4, v15
  buffer_load_dwordx3 v[108:110], v1, s[32:35], s46 offen nt
  s_addk_i32 s46, 6144
  s_nop 0
  v_permlane16_swap_b32 v11, v15
  v_add_f32 v19, v11, v15
  s_waitcnt vmcnt(31)
  v_dot2_f32_bf16 v11, v112, v2, 0
  v_dot2_f32_bf16 v11, v113, v3, v11
  v_dot2_f32_bf16 v11, v114, v4, v11
  buffer_load_dwordx3 v[112:114], v1, s[32:35], s46 offen nt
  s_addk_i32 s46, 6144
  s_waitcnt vmcnt(31)
  v_dot2_f32_bf16 v15, v116, v2, 0
  v_dot2_f32_bf16 v15, v117, v3, v15
  v_dot2_f32_bf16 v15, v118, v4, v15
  buffer_load_dwordx3 v[116:118], v1, s[32:35], s46 offen nt
  s_addk_i32 s46, 6144
  s_nop 0
  v_permlane16_swap_b32 v11, v15
  v_add_f32 v23, v11, v15
  v_add_f32_dpp v27, v19, v19 row_ror:8 row_mask:0xf bank_mask:0x3
  s_nop 0
  v_add_f32_dpp v27, v23, v23 row_ror:8 row_mask:0xf bank_mask:0xc
  s_waitcnt vmcnt(31)
  v_dot2_f32_bf16 v11, v120, v2, 0
  v_dot2_f32_bf16 v11, v121, v3, v11
  v_dot2_f32_bf16 v11, v122, v4, v11
  buffer_load_dwordx3 v[120:122], v1, s[32:35], s46 offen nt
  s_addk_i32 s46, 6144
  s_waitcnt vmcnt(31)
  v_dot2_f32_bf16 v15, v124, v2, 0
  v_dot2_f32_bf16 v15, v125, v3, v15
  v_dot2_f32_bf16 v15, v126, v4, v15
  buffer_load_dwordx3 v[124:126], v1, s[32:35], s46 offen nt
  s_addk_i32 s46, 6144
  s_nop 0
  v_permlane16_swap_b32 v11, v15
  v_add_f32 v19, v11, v15
  s_waitcnt vmcnt(31)
  v_dot2_f32_bf16 v11, v128, v2, 0
  v_dot2_f32_bf16 v11, v129, v3, v11
  v_dot2_f32_bf16 v11, v130, v4, v11
  buffer_load_dwordx3 v[128:130], v1, s[32:35], s46 offen nt
  s_addk_i32 s46, 6144
  s_waitcnt vmcnt(31)
  v_dot2_f32_bf16 v15, v132, v2, 0
  v_dot2_f32_bf16 v15, v133, v3, v15
  v_dot2_f32_bf16 v15, v134, v4, v15
  buffer_load_dwordx3 v[132:134], v1, s[32:35], s46 offen nt
  s_addk_i32 s46, 6144
  s_nop 0
  v_permlane16_swap_b32 v11, v15
  v_add_f32 v23, v11, v15
  v_add_f32_dpp v31, v19, v19 row_ror:8 row_mask:0xf bank_mask:0x3
  s_nop 0
  v_add_f32_dpp v31, v23, v23 row_ror:8 row_mask:0xf bank_mask:0xc
  v_add_f32_dpp v47, v27, v27 row_half_mirror row_mask:0xf bank_mask:0x5
  s_nop 0
  v_add_f32_dpp v47, v31, v31 row_half_mirror row_mask:0xf bank_mask:0xa
  v_add_f32_dpp v59, v43, v43 quad_perm:[1,0,3,2] row_mask:0xf bank_mask:0xf
  s_nop 0
  v_add_f32_dpp v63, v47, v47 quad_perm:[1,0,3,2] row_mask:0xf bank_mask:0xf
  v_cndmask_b32 v55, v59, v63, s[48:49]
  v_add_f32_dpp v59, v51, v51 quad_perm:[2,3,0,1] row_mask:0xf bank_mask:0xf
  s_nop 0
  v_add_f32_dpp v63, v55, v55 quad_perm:[2,3,0,1] row_mask:0xf bank_mask:0xf
  v_cndmask_b32 v103, v59, v63, s[50:51]
  s_waitcnt vmcnt(31)
  v_dot2_f32_bf16 v11, v8, v2, 0
  v_dot2_f32_bf16 v11, v9, v3, v11
  v_dot2_f32_bf16 v11, v10, v4, v11
  buffer_load_dwordx3 v[8:10], v1, s[32:35], s46 offen nt
  s_addk_i32 s46, 6144
  s_waitcnt vmcnt(31)
  v_dot2_f32_bf16 v15, v12, v2, 0
  v_dot2_f32_bf16 v15, v13, v3, v15
  v_dot2_f32_bf16 v15, v14, v4, v15
  buffer_load_dwordx3 v[12:14], v1, s[32:35], s46 offen nt
  s_addk_i32 s46, 6144
  s_nop 0
  v_permlane16_swap_b32 v11, v15
  v_add_f32 v19, v11, v15
  s_waitcnt vmcnt(31)
  v_dot2_f32_bf16 v11, v16, v2, 0
  v_dot2_f32_bf16 v11, v17, v3, v11
  v_dot2_f32_bf16 v11, v18, v4, v11
  buffer_load_dwordx3 v[16:18], v1, s[32:35], s46 offen nt
  s_addk_i32 s46, 6144
  s_waitcnt vmcnt(31)
  v_dot2_f32_bf16 v15, v20, v2, 0
  v_dot2_f32_bf16 v15, v21, v3, v15
  v_dot2_f32_bf16 v15, v22, v4, v15
  buffer_load_dwordx3 v[20:22], v1, s[32:35], s46 offen nt
  s_addk_i32 s46, 6144
  s_nop 0
  v_permlane16_swap_b32 v11, v15
  v_add_f32 v23, v11, v15
  v_add_f32_dpp v27, v19, v19 row_ror:8 row_mask:0xf bank_mask:0x3
  s_nop 0
  v_add_f32_dpp v27, v23, v23 row_ror:8 row_mask:0xf bank_mask:0xc
  s_waitcnt vmcnt(31)
  v_dot2_f32_bf16 v11, v24, v2, 0
  v_dot2_f32_bf16 v11, v25, v3, v11
  v_dot2_f32_bf16 v11, v26, v4, v11
  buffer_load_dwordx3 v[24:26], v1, s[32:35], s46 offen nt
  s_addk_i32 s46, 6144
  s_waitcnt vmcnt(31)
  v_dot2_f32_bf16 v15, v28, v2, 0
  v_dot2_f32_bf16 v15, v29, v3, v15
  v_dot2_f32_bf16 v15, v30, v4, v15
  buffer_load_dwordx3 v[28:30], v1, s[32:35], s46 offen nt
  s_addk_i32 s46, 6144
  s_nop 0
  v_permlane16_swap_b32 v11, v15
  v_add_f32 v19, v11, v15
  s_waitcnt vmcnt(31)
  v_dot2_f32_bf16 v11, v32, v2, 0
  v_dot2_f32_bf16 v11, v33, v3, v11
  v_dot2_f32_bf16 v11, v34, v4, v11
  buffer_load_dwordx3 v[32:34], v1, s[32:35], s46 offen nt
  s_addk_i32 s46, 6144
  s_waitcnt vmcnt(31)
  v_dot2_f32_bf16 v15, v36, v2, 0
  v_dot2_f32_bf16 v15, v37, v3, v15
  v_dot2_f32_bf16 v15, v38, v4, v15
  buffer_load_dwordx3 v[36:38], v1, s[32:35], s46 offen nt
  s_addk_i32 s46, 6144
  s_nop 0
  v_permlane16_swap_b32 v11, v15
  v_add_f32 v23, v11, v15
  v_add_f32_dpp v31, v19, v19 row_ror:8 row_mask:0xf bank_mask:0x3
  s_nop 0
  v_add_f32_dpp v31, v23, v23 row_ror:8 row_mask:0xf bank_mask:0xc
  v_add_f32_dpp v35, v27, v27 row_half_mirror row_mask:0xf bank_mask:0x5
  s_nop 0
  v_add_f32_dpp v35, v31, v31 row_half_mirror row_mask:0xf bank_mask:0xa
  s_waitcnt vmcnt(31)
  v_dot2_f32_bf16 v11, v40, v2, 0
  v_dot2_f32_bf16 v11, v41, v3, v11
  v_dot2_f32_bf16 v11, v42, v4, v11
  buffer_load_dwordx3 v[40:42], v1, s[32:35], s46 offen nt
  s_addk_i32 s46, 6144
  s_waitcnt vmcnt(31)
  v_dot2_f32_bf16 v15, v44, v2, 0
  v_dot2_f32_bf16 v15, v45, v3, v15
  v_dot2_f32_bf16 v15, v46, v4, v15
  buffer_load_dwordx3 v[44:46], v1, s[32:35], s46 offen nt
  s_addk_i32 s46, 6144
  s_nop 0
  v_permlane16_swap_b32 v11, v15
  v_add_f32 v19, v11, v15
  s_waitcnt vmcnt(31)
  v_dot2_f32_bf16 v11, v48, v2, 0
  v_dot2_f32_bf16 v11, v49, v3, v11
  v_dot2_f32_bf16 v11, v50, v4, v11
  buffer_load_dwordx3 v[48:50], v1, s[32:35], s46 offen nt
  s_addk_i32 s46, 6144
  s_waitcnt vmcnt(31)
  v_dot2_f32_bf16 v15, v52, v2, 0
  v_dot2_f32_bf16 v15, v53, v3, v15
  v_dot2_f32_bf16 v15, v54, v4, v15
  buffer_load_dwordx3 v[52:54], v1, s[32:35], s46 offen nt
  s_addk_i32 s46, 6144
  s_nop 0
  v_permlane16_swap_b32 v11, v15
  v_add_f32 v23, v11, v15
  v_add_f32_dpp v27, v19, v19 row_ror:8 row_mask:0xf bank_mask:0x3
  s_nop 0
  v_add_f32_dpp v27, v23, v23 row_ror:8 row_mask:0xf bank_mask:0xc
  s_waitcnt vmcnt(31)
  v_dot2_f32_bf16 v11, v56, v2, 0
  v_dot2_f32_bf16 v11, v57, v3, v11
  v_dot2_f32_bf16 v11, v58, v4, v11
  buffer_load_dwordx3 v[56:58], v1, s[32:35], s46 offen nt
  s_addk_i32 s46, 6144
  s_waitcnt vmcnt(31)
  v_dot2_f32_bf16 v15, v60, v2, 0
  v_dot2_f32_bf16 v15, v61, v3, v15
  v_dot2_f32_bf16 v15, v62, v4, v15
  buffer_load_dwordx3 v[60:62], v1, s[32:35], s46 offen nt
  s_addk_i32 s46, 6144
  s_nop 0
  v_permlane16_swap_b32 v11, v15
  v_add_f32 v19, v11, v15
  s_waitcnt vmcnt(31)
  v_dot2_f32_bf16 v11, v64, v2, 0
  v_dot2_f32_bf16 v11, v65, v3, v11
  v_dot2_f32_bf16 v11, v66, v4, v11
  buffer_load_dwordx3 v[64:66], v1, s[32:35], s46 offen nt
  s_addk_i32 s46, 6144
  s_waitcnt vmcnt(31)
  v_dot2_f32_bf16 v15, v68, v2, 0
  v_dot2_f32_bf16 v15, v69, v3, v15
  v_dot2_f32_bf16 v15, v70, v4, v15
  buffer_load_dwordx3 v[68:70], v1, s[32:35], s46 offen nt
  s_addk_i32 s46, 6144
  s_nop 0
  v_permlane16_swap_b32 v11, v15
  v_add_f32 v23, v11, v15
  v_add_f32_dpp v31, v19, v19 row_ror:8 row_mask:0xf bank_mask:0x3
  s_nop 0
  v_add_f32_dpp v31, v23, v23 row_ror:8 row_mask:0xf bank_mask:0xc
  v_add_f32_dpp v39, v27, v27 row_half_mirror row_mask:0xf bank_mask:0x5
  s_nop 0
  v_add_f32_dpp v39, v31, v31 row_half_mirror row_mask:0xf bank_mask:0xa
  v_add_f32_dpp v59, v35, v35 quad_perm:[1,0,3,2] row_mask:0xf bank_mask:0xf
  s_nop 0
  v_add_f32_dpp v63, v39, v39 quad_perm:[1,0,3,2] row_mask:0xf bank_mask:0xf
  v_cndmask_b32 v51, v59, v63, s[48:49]
  s_waitcnt vmcnt(31)
  v_dot2_f32_bf16 v11, v72, v2, 0
  v_dot2_f32_bf16 v11, v73, v3, v11
  v_dot2_f32_bf16 v11, v74, v4, v11
  buffer_load_dwordx3 v[72:74], v1, s[32:35], s46 offen nt
  s_addk_i32 s46, 6144
  s_waitcnt vmcnt(31)
  v_dot2_f32_bf16 v15, v76, v2, 0
  v_dot2_f32_bf16 v15, v77, v3, v15
  v_dot2_f32_bf16 v15, v78, v4, v15
  buffer_load_dwordx3 v[76:78], v1, s[32:35], s46 offen nt
  s_addk_i32 s46, 6144
  s_nop 0
  v_permlane16_swap_b32 v11, v15
  v_add_f32 v19, v11, v15
  s_waitcnt vmcnt(31)
  v_dot2_f32_bf16 v11, v80, v2, 0
  v_dot2_f32_bf16 v11, v81, v3, v11
  v_dot2_f32_bf16 v11, v82, v4, v11
  buffer_load_dwordx3 v[80:82], v1, s[32:35], s46 offen nt
  s_addk_i32 s46, 6144
  s_waitcnt vmcnt(31)
  v_dot2_f32_bf16 v15, v84, v2, 0
  v_dot2_f32_bf16 v15, v85, v3, v15
  v_dot2_f32_bf16 v15, v86, v4, v15
  buffer_load_dwordx3 v[84:86], v1, s[32:35], s46 offen nt
  s_addk_i32 s46, 6144
  s_nop 0
  v_permlane16_swap_b32 v11, v15
  v_add_f32 v23, v11, v15
  v_add_f32_dpp v27, v19, v19 row_ror:8 row_mask:0xf bank_mask:0x3
  s_nop 0
  v_add_f32_dpp v27, v23, v23 row_ror:8 row_mask:0xf bank_mask:0xc
  s_waitcnt vmcnt(31)
  v_dot2_f32_bf16 v11, v88, v2, 0
  v_dot2_f32_bf16 v11, v89, v3, v11
  v_dot2_f32_bf16 v11, v90, v4, v11
  buffer_load_dwordx3 v[88:90], v1, s[32:35], s46 offen nt
  s_addk_i32 s46, 6144
  s_waitcnt vmcnt(31)
  v_dot2_f32_bf16 v15, v92, v2, 0
  v_dot2_f32_bf16 v15, v93, v3, v15
  v_dot2_f32_bf16 v15, v94, v4, v15
  buffer_load_dwordx3 v[92:94], v1, s[32:35], s46 offen nt
  s_addk_i32 s46, 6144
  s_nop 0
  v_permlane16_swap_b32 v11, v15
  v_add_f32 v19, v11, v15
  s_waitcnt vmcnt(31)
  v_dot2_f32_bf16 v11, v96, v2, 0
  v_dot2_f32_bf16 v11, v97, v3, v11
  v_dot2_f32_bf16 v11, v98, v4, v11
  buffer_load_dwordx3 v[96:98], v1, s[32:35], s46 offen nt
  s_addk_i32 s46, 6144
  s_waitcnt vmcnt(31)
  v_dot2_f32_bf16 v15, v100, v2, 0
  v_dot2_f32_bf16 v15, v101, v3, v15
  v_dot2_f32_bf16 v15, v102, v4, v15
  buffer_load_dwordx3 v[100:102], v1, s[32:35], s46 offen nt
  s_addk_i32 s46, 6144
  s_nop 0
  v_permlane16_swap_b32 v11, v15
  v_add_f32 v23, v11, v15
  v_add_f32_dpp v31, v19, v19 row_ror:8 row_mask:0xf bank_mask:0x3
  s_nop 0
  v_add_f32_dpp v31, v23, v23 row_ror:8 row_mask:0xf bank_mask:0xc
  v_add_f32_dpp v43, v27, v27 row_half_mirror row_mask:0xf bank_mask:0x5
  s_nop 0
  v_add_f32_dpp v43, v31, v31 row_half_mirror row_mask:0xf bank_mask:0xa
  s_waitcnt vmcnt(31)
  v_dot2_f32_bf16 v11, v104, v2, 0
  v_dot2_f32_bf16 v11, v105, v3, v11
  v_dot2_f32_bf16 v11, v106, v4, v11
  buffer_load_dwordx3 v[104:106], v1, s[32:35], s46 offen nt
  s_addk_i32 s46, 6144
  s_waitcnt vmcnt(31)
  v_dot2_f32_bf16 v15, v108, v2, 0
  v_dot2_f32_bf16 v15, v109, v3, v15
  v_dot2_f32_bf16 v15, v110, v4, v15
  buffer_load_dwordx3 v[108:110], v1, s[32:35], s46 offen nt
  s_addk_i32 s46, 6144
  s_nop 0
  v_permlane16_swap_b32 v11, v15
  v_add_f32 v19, v11, v15
  s_waitcnt vmcnt(31)
  v_dot2_f32_bf16 v11, v112, v2, 0
  v_dot2_f32_bf16 v11, v113, v3, v11
  v_dot2_f32_bf16 v11, v114, v4, v11
  buffer_load_dwordx3 v[112:114], v1, s[32:35], s46 offen nt
  s_addk_i32 s46, 6144
  s_waitcnt vmcnt(31)
  v_dot2_f32_bf16 v15, v116, v2, 0
  v_dot2_f32_bf16 v15, v117, v3, v15
  v_dot2_f32_bf16 v15, v118, v4, v15
  buffer_load_dwordx3 v[116:118], v1, s[32:35], s46 offen nt
  s_addk_i32 s46, 6144
  s_nop 0
  v_permlane16_swap_b32 v11, v15
  v_add_f32 v23, v11, v15
  v_add_f32_dpp v27, v19, v19 row_ror:8 row_mask:0xf bank_mask:0x3
  s_nop 0
  v_add_f32_dpp v27, v23, v23 row_ror:8 row_mask:0xf bank_mask:0xc
  s_waitcnt vmcnt(31)
  v_dot2_f32_bf16 v11, v120, v2, 0
  v_dot2_f32_bf16 v11, v121, v3, v11
  v_dot2_f32_bf16 v11, v122, v4, v11
  buffer_load_dwordx3 v[120:122], v1, s[32:35], s46 offen nt
  s_addk_i32 s46, 6144
  s_waitcnt vmcnt(31)
  v_dot2_f32_bf16 v15, v124, v2, 0
  v_dot2_f32_bf16 v15, v125, v3, v15
  v_dot2_f32_bf16 v15, v126, v4, v15
  buffer_load_dwordx3 v[124:126], v1, s[32:35], s46 offen nt
  s_addk_i32 s46, 6144
  s_nop 0
  v_permlane16_swap_b32 v11, v15
  v_add_f32 v19, v11, v15
  s_waitcnt vmcnt(31)
  v_dot2_f32_bf16 v11, v128, v2, 0
  v_dot2_f32_bf16 v11, v129, v3, v11
  v_dot2_f32_bf16 v11, v130, v4, v11
  buffer_load_dwordx3 v[128:130], v1, s[32:35], s46 offen nt
  s_addk_i32 s46, 6144
  s_waitcnt vmcnt(31)
  v_dot2_f32_bf16 v15, v132, v2, 0
  v_dot2_f32_bf16 v15, v133, v3, v15
  v_dot2_f32_bf16 v15, v134, v4, v15
  buffer_load_dwordx3 v[132:134], v1, s[32:35], s46 offen nt
  s_addk_i32 s46, 6144
  s_nop 0
  v_permlane16_swap_b32 v11, v15
  v_add_f32 v23, v11, v15
  v_add_f32_dpp v31, v19, v19 row_ror:8 row_mask:0xf bank_mask:0x3
  s_nop 0
  v_add_f32_dpp v31, v23, v23 row_ror:8 row_mask:0xf bank_mask:0xc
  v_add_f32_dpp v47, v27, v27 row_half_mirror row_mask:0xf bank_mask:0x5
  s_nop 0
  v_add_f32_dpp v47, v31, v31 row_half_mirror row_mask:0xf bank_mask:0xa
  v_add_f32_dpp v59, v43, v43 quad_perm:[1,0,3,2] row_mask:0xf bank_mask:0xf
  s_nop 0
  v_add_f32_dpp v63, v47, v47 quad_perm:[1,0,3,2] row_mask:0xf bank_mask:0xf
  v_cndmask_b32 v55, v59, v63, s[48:49]
  v_add_f32_dpp v59, v51, v51 quad_perm:[2,3,0,1] row_mask:0xf bank_mask:0xf
  s_nop 0
  v_add_f32_dpp v63, v55, v55 quad_perm:[2,3,0,1] row_mask:0xf bank_mask:0xf
  v_cndmask_b32 v107, v59, v63, s[50:51]
  s_waitcnt vmcnt(31)
  v_dot2_f32_bf16 v11, v8, v2, 0
  v_dot2_f32_bf16 v11, v9, v3, v11
  v_dot2_f32_bf16 v11, v10, v4, v11
  buffer_load_dwordx3 v[8:10], v1, s[32:35], s46 offen nt
  s_addk_i32 s46, 6144
  s_waitcnt vmcnt(31)
  v_dot2_f32_bf16 v15, v12, v2, 0
  v_dot2_f32_bf16 v15, v13, v3, v15
  v_dot2_f32_bf16 v15, v14, v4, v15
  buffer_load_dwordx3 v[12:14], v1, s[32:35], s46 offen nt
  s_addk_i32 s46, 6144
  s_nop 0
  v_permlane16_swap_b32 v11, v15
  v_add_f32 v19, v11, v15
  s_waitcnt vmcnt(31)
  v_dot2_f32_bf16 v11, v16, v2, 0
  v_dot2_f32_bf16 v11, v17, v3, v11
  v_dot2_f32_bf16 v11, v18, v4, v11
  buffer_load_dwordx3 v[16:18], v1, s[32:35], s46 offen nt
  s_addk_i32 s46, 6144
  s_waitcnt vmcnt(31)
  v_dot2_f32_bf16 v15, v20, v2, 0
  v_dot2_f32_bf16 v15, v21, v3, v15
  v_dot2_f32_bf16 v15, v22, v4, v15
  buffer_load_dwordx3 v[20:22], v1, s[32:35], s46 offen nt
  s_nop 1
  v_permlane16_swap_b32 v11, v15
  v_add_f32 v23, v11, v15
  v_add_f32_dpp v27, v19, v19 row_ror:8 row_mask:0xf bank_mask:0x3
  s_nop 0
  v_add_f32_dpp v27, v23, v23 row_ror:8 row_mask:0xf bank_mask:0xc
  s_waitcnt vmcnt(31)
  v_dot2_f32_bf16 v11, v24, v2, 0
  v_dot2_f32_bf16 v11, v25, v3, v11
  v_dot2_f32_bf16 v11, v26, v4, v11
  s_mov_b32 s46, 0
  buffer_load_dwordx3 v[24:26], v1, s[36:39], s46 offen nt
  s_addk_i32 s46, 6144
  s_waitcnt vmcnt(31)
  v_dot2_f32_bf16 v15, v28, v2, 0
  v_dot2_f32_bf16 v15, v29, v3, v15
  v_dot2_f32_bf16 v15, v30, v4, v15
  buffer_load_dwordx3 v[28:30], v1, s[36:39], s46 offen nt
  s_addk_i32 s46, 6144
  s_nop 0
  v_permlane16_swap_b32 v11, v15
  v_add_f32 v19, v11, v15
  s_waitcnt vmcnt(31)
  v_dot2_f32_bf16 v11, v32, v2, 0
  v_dot2_f32_bf16 v11, v33, v3, v11
  v_dot2_f32_bf16 v11, v34, v4, v11
  buffer_load_dwordx3 v[32:34], v1, s[36:39], s46 offen nt
  s_addk_i32 s46, 6144
  s_waitcnt vmcnt(31)
  v_dot2_f32_bf16 v15, v36, v2, 0
  v_dot2_f32_bf16 v15, v37, v3, v15
  v_dot2_f32_bf16 v15, v38, v4, v15
  buffer_load_dwordx3 v[36:38], v1, s[36:39], s46 offen nt
  s_addk_i32 s46, 6144
  s_nop 0
  v_permlane16_swap_b32 v11, v15
  v_add_f32 v23, v11, v15
  v_add_f32_dpp v31, v19, v19 row_ror:8 row_mask:0xf bank_mask:0x3
  s_nop 0
  v_add_f32_dpp v31, v23, v23 row_ror:8 row_mask:0xf bank_mask:0xc
  v_add_f32_dpp v35, v27, v27 row_half_mirror row_mask:0xf bank_mask:0x5
  s_nop 0
  v_add_f32_dpp v35, v31, v31 row_half_mirror row_mask:0xf bank_mask:0xa
  s_waitcnt vmcnt(31)
  v_dot2_f32_bf16 v11, v40, v2, 0
  v_dot2_f32_bf16 v11, v41, v3, v11
  v_dot2_f32_bf16 v11, v42, v4, v11
  buffer_load_dwordx3 v[40:42], v1, s[36:39], s46 offen nt
  s_addk_i32 s46, 6144
  s_waitcnt vmcnt(31)
  v_dot2_f32_bf16 v15, v44, v2, 0
  v_dot2_f32_bf16 v15, v45, v3, v15
  v_dot2_f32_bf16 v15, v46, v4, v15
  buffer_load_dwordx3 v[44:46], v1, s[36:39], s46 offen nt
  s_addk_i32 s46, 6144
  s_nop 0
  v_permlane16_swap_b32 v11, v15
  v_add_f32 v19, v11, v15
  s_waitcnt vmcnt(31)
  v_dot2_f32_bf16 v11, v48, v2, 0
  v_dot2_f32_bf16 v11, v49, v3, v11
  v_dot2_f32_bf16 v11, v50, v4, v11
  buffer_load_dwordx3 v[48:50], v1, s[36:39], s46 offen nt
  s_addk_i32 s46, 6144
  s_waitcnt vmcnt(31)
  v_dot2_f32_bf16 v15, v52, v2, 0
  v_dot2_f32_bf16 v15, v53, v3, v15
  v_dot2_f32_bf16 v15, v54, v4, v15
  buffer_load_dwordx3 v[52:54], v1, s[36:39], s46 offen nt
  s_addk_i32 s46, 6144
  s_nop 0
  v_permlane16_swap_b32 v11, v15
  v_add_f32 v23, v11, v15
  v_add_f32_dpp v27, v19, v19 row_ror:8 row_mask:0xf bank_mask:0x3
  s_nop 0
  v_add_f32_dpp v27, v23, v23 row_ror:8 row_mask:0xf bank_mask:0xc
  s_waitcnt vmcnt(31)
  v_dot2_f32_bf16 v11, v56, v2, 0
  v_dot2_f32_bf16 v11, v57, v3, v11
  v_dot2_f32_bf16 v11, v58, v4, v11
  buffer_load_dwordx3 v[56:58], v1, s[36:39], s46 offen nt
  s_addk_i32 s46, 6144
  s_waitcnt vmcnt(31)
  v_dot2_f32_bf16 v15, v60, v2, 0
  v_dot2_f32_bf16 v15, v61, v3, v15
  v_dot2_f32_bf16 v15, v62, v4, v15
  buffer_load_dwordx3 v[60:62], v1, s[36:39], s46 offen nt
  s_addk_i32 s46, 6144
  s_nop 0
  v_permlane16_swap_b32 v11, v15
  v_add_f32 v19, v11, v15
  s_waitcnt vmcnt(31)
  v_dot2_f32_bf16 v11, v64, v2, 0
  v_dot2_f32_bf16 v11, v65, v3, v11
  v_dot2_f32_bf16 v11, v66, v4, v11
  buffer_load_dwordx3 v[64:66], v1, s[36:39], s46 offen nt
  s_addk_i32 s46, 6144
  s_waitcnt vmcnt(31)
  v_dot2_f32_bf16 v15, v68, v2, 0
  v_dot2_f32_bf16 v15, v69, v3, v15
  v_dot2_f32_bf16 v15, v70, v4, v15
  buffer_load_dwordx3 v[68:70], v1, s[36:39], s46 offen nt
  s_addk_i32 s46, 6144
  s_nop 0
  v_permlane16_swap_b32 v11, v15
  v_add_f32 v23, v11, v15
  v_add_f32_dpp v31, v19, v19 row_ror:8 row_mask:0xf bank_mask:0x3
  s_nop 0
  v_add_f32_dpp v31, v23, v23 row_ror:8 row_mask:0xf bank_mask:0xc
  v_add_f32_dpp v39, v27, v27 row_half_mirror row_mask:0xf bank_mask:0x5
  s_nop 0
  v_add_f32_dpp v39, v31, v31 row_half_mirror row_mask:0xf bank_mask:0xa
  v_add_f32_dpp v59, v35, v35 quad_perm:[1,0,3,2] row_mask:0xf bank_mask:0xf
  s_nop 0
  v_add_f32_dpp v63, v39, v39 quad_perm:[1,0,3,2] row_mask:0xf bank_mask:0xf
  v_cndmask_b32 v51, v59, v63, s[48:49]
  s_waitcnt vmcnt(31)
  v_dot2_f32_bf16 v11, v72, v2, 0
  v_dot2_f32_bf16 v11, v73, v3, v11
  v_dot2_f32_bf16 v11, v74, v4, v11
  s_waitcnt vmcnt(30)
  v_dot2_f32_bf16 v15, v76, v2, 0
  v_dot2_f32_bf16 v15, v77, v3, v15
  v_dot2_f32_bf16 v15, v78, v4, v15
  s_nop 2
  v_permlane16_swap_b32 v11, v15
  v_add_f32 v19, v11, v15
  s_waitcnt vmcnt(29)
  v_dot2_f32_bf16 v11, v80, v2, 0
  v_dot2_f32_bf16 v11, v81, v3, v11
  v_dot2_f32_bf16 v11, v82, v4, v11
  s_waitcnt vmcnt(28)
  v_dot2_f32_bf16 v15, v84, v2, 0
  v_dot2_f32_bf16 v15, v85, v3, v15
  v_dot2_f32_bf16 v15, v86, v4, v15
  s_nop 2
  v_permlane16_swap_b32 v11, v15
  v_add_f32 v23, v11, v15
  v_add_f32_dpp v27, v19, v19 row_ror:8 row_mask:0xf bank_mask:0x3
  s_nop 0
  v_add_f32_dpp v27, v23, v23 row_ror:8 row_mask:0xf bank_mask:0xc
  s_waitcnt vmcnt(27)
  v_dot2_f32_bf16 v11, v88, v2, 0
  v_dot2_f32_bf16 v11, v89, v3, v11
  v_dot2_f32_bf16 v11, v90, v4, v11
  s_waitcnt vmcnt(26)
  v_dot2_f32_bf16 v15, v92, v2, 0
  v_dot2_f32_bf16 v15, v93, v3, v15
  v_dot2_f32_bf16 v15, v94, v4, v15
  s_nop 2
  v_permlane16_swap_b32 v11, v15
  v_add_f32 v19, v11, v15
  s_waitcnt vmcnt(25)
  v_dot2_f32_bf16 v11, v96, v2, 0
  v_dot2_f32_bf16 v11, v97, v3, v11
  v_dot2_f32_bf16 v11, v98, v4, v11
  s_waitcnt vmcnt(24)
  v_dot2_f32_bf16 v15, v100, v2, 0
  v_dot2_f32_bf16 v15, v101, v3, v15
  v_dot2_f32_bf16 v15, v102, v4, v15
  s_nop 2
  v_permlane16_swap_b32 v11, v15
  v_add_f32 v23, v11, v15
  v_add_f32_dpp v31, v19, v19 row_ror:8 row_mask:0xf bank_mask:0x3
  s_nop 0
  v_add_f32_dpp v31, v23, v23 row_ror:8 row_mask:0xf bank_mask:0xc
  v_add_f32_dpp v43, v27, v27 row_half_mirror row_mask:0xf bank_mask:0x5
  s_nop 0
  v_add_f32_dpp v43, v31, v31 row_half_mirror row_mask:0xf bank_mask:0xa
  s_waitcnt vmcnt(23)
  v_dot2_f32_bf16 v11, v104, v2, 0
  v_dot2_f32_bf16 v11, v105, v3, v11
  v_dot2_f32_bf16 v11, v106, v4, v11
  s_waitcnt vmcnt(22)
  v_dot2_f32_bf16 v15, v108, v2, 0
  v_dot2_f32_bf16 v15, v109, v3, v15
  v_dot2_f32_bf16 v15, v110, v4, v15
  s_nop 2
  v_permlane16_swap_b32 v11, v15
  v_add_f32 v19, v11, v15
  s_waitcnt vmcnt(21)
  v_dot2_f32_bf16 v11, v112, v2, 0
  v_dot2_f32_bf16 v11, v113, v3, v11
  v_dot2_f32_bf16 v11, v114, v4, v11
  s_waitcnt vmcnt(20)
  v_dot2_f32_bf16 v15, v116, v2, 0
  v_dot2_f32_bf16 v15, v117, v3, v15
  v_dot2_f32_bf16 v15, v118, v4, v15
  s_nop 2
  v_permlane16_swap_b32 v11, v15
  v_add_f32 v23, v11, v15
  v_add_f32_dpp v27, v19, v19 row_ror:8 row_mask:0xf bank_mask:0x3
  s_nop 0
  v_add_f32_dpp v27, v23, v23 row_ror:8 row_mask:0xf bank_mask:0xc
  s_waitcnt vmcnt(19)
  v_dot2_f32_bf16 v11, v120, v2, 0
  v_dot2_f32_bf16 v11, v121, v3, v11
  v_dot2_f32_bf16 v11, v122, v4, v11
  s_waitcnt vmcnt(18)
  v_dot2_f32_bf16 v15, v124, v2, 0
  v_dot2_f32_bf16 v15, v125, v3, v15
  v_dot2_f32_bf16 v15, v126, v4, v15
  s_nop 2
  v_permlane16_swap_b32 v11, v15
  v_add_f32 v19, v11, v15
  s_waitcnt vmcnt(17)
  v_dot2_f32_bf16 v11, v128, v2, 0
  v_dot2_f32_bf16 v11, v129, v3, v11
  v_dot2_f32_bf16 v11, v130, v4, v11
  s_waitcnt vmcnt(16)
  v_dot2_f32_bf16 v15, v132, v2, 0
  v_dot2_f32_bf16 v15, v133, v3, v15
  v_dot2_f32_bf16 v15, v134, v4, v15
  s_nop 2
  v_permlane16_swap_b32 v11, v15
  v_add_f32 v23, v11, v15
  v_add_f32_dpp v31, v19, v19 row_ror:8 row_mask:0xf bank_mask:0x3
  s_nop 0
  v_add_f32_dpp v31, v23, v23 row_ror:8 row_mask:0xf bank_mask:0xc
  v_add_f32_dpp v47, v27, v27 row_half_mirror row_mask:0xf bank_mask:0x5
  s_nop 0
  v_add_f32_dpp v47, v31, v31 row_half_mirror row_mask:0xf bank_mask:0xa
  v_add_f32_dpp v59, v43, v43 quad_perm:[1,0,3,2] row_mask:0xf bank_mask:0xf
  s_nop 0
  v_add_f32_dpp v63, v47, v47 quad_perm:[1,0,3,2] row_mask:0xf bank_mask:0xf
  v_cndmask_b32 v55, v59, v63, s[48:49]
  v_add_f32_dpp v59, v51, v51 quad_perm:[2,3,0,1] row_mask:0xf bank_mask:0xf
  s_nop 0
  v_add_f32_dpp v63, v55, v55 quad_perm:[2,3,0,1] row_mask:0xf bank_mask:0xf
  v_cndmask_b32 v111, v59, v63, s[50:51]
  s_waitcnt vmcnt(15)
  v_dot2_f32_bf16 v11, v8, v2, 0
  v_dot2_f32_bf16 v11, v9, v3, v11
  v_dot2_f32_bf16 v11, v10, v4, v11
  s_waitcnt vmcnt(14)
  v_dot2_f32_bf16 v15, v12, v2, 0
  v_dot2_f32_bf16 v15, v13, v3, v15
  v_dot2_f32_bf16 v15, v14, v4, v15
  s_nop 2
  v_permlane16_swap_b32 v11, v15
  v_add_f32 v19, v11, v15
  s_waitcnt vmcnt(13)
  v_dot2_f32_bf16 v11, v16, v2, 0
  v_dot2_f32_bf16 v11, v17, v3, v11
  v_dot2_f32_bf16 v11, v18, v4, v11
  s_waitcnt vmcnt(12)
  v_dot2_f32_bf16 v15, v20, v2, 0
  v_dot2_f32_bf16 v15, v21, v3, v15
  v_dot2_f32_bf16 v15, v22, v4, v15
  s_nop 2
  v_permlane16_swap_b32 v11, v15
  v_add_f32 v23, v11, v15
  v_add_f32_dpp v27, v19, v19 row_ror:8 row_mask:0xf bank_mask:0x3
  s_nop 0
  v_add_f32_dpp v27, v23, v23 row_ror:8 row_mask:0xf bank_mask:0xc
  s_nop 1
  v_add_f32_dpp v35, v27, v27 row_half_mirror row_mask:0xf bank_mask:0x5
  v_add_f32_dpp v35, v31, v31 row_half_mirror row_mask:0xf bank_mask:0xa
  s_nop 1
  v_add_f32_dpp v59, v35, v35 quad_perm:[1,0,3,2] row_mask:0xf bank_mask:0xf
  v_add_f32_dpp v63, v39, v39 quad_perm:[1,0,3,2] row_mask:0xf bank_mask:0xf
  v_cndmask_b32 v51, v59, v63, s[48:49]
  s_nop 1
  v_add_f32_dpp v59, v51, v51 quad_perm:[2,3,0,1] row_mask:0xf bank_mask:0xf
  v_add_f32_dpp v63, v55, v55 quad_perm:[2,3,0,1] row_mask:0xf bank_mask:0xf
  v_cndmask_b32 v156, v59, v63, s[50:51]
  v_cvt_pk_bf16_f32 v6, v99, v103
  v_cvt_pk_bf16_f32 v7, v107, v111
  v_lshlrev_b32 v99, 16, v6
  v_and_b32 v103, 0xffff0000, v6
  v_lshlrev_b32 v107, 16, v7
  v_and_b32 v111, 0xffff0000, v7
  s_mov_b32 s45, 0x3d93cd3a
  v_mul_f32 v99, s45, v99
  v_mul_f32 v103, s45, v103
  v_mul_f32 v107, s45, v107
  v_mul_f32 v111, s45, v111
  v_cvt_pk_bf16_f32 v6, v99, v103
  v_cvt_pk_bf16_f32 v7, v107, v111
  v_lshlrev_b32 v99, 16, v6
  v_and_b32 v103, 0xffff0000, v6
  v_lshlrev_b32 v107, 16, v7
  v_and_b32 v111, 0xffff0000, v7
  v_cvt_pk_bf16_f32 v6, v156, v156
  v_lshlrev_b32 v156, 16, v6
  v_mul_f32 v156, s45, v156
  v_cvt_pk_bf16_f32 v6, v156, v156
  v_lshlrev_b32 v156, 16, v6
  v_mov_b32 v7, 0xff800000
  s_cmp_eq_u32 s59, 0
  s_cselect_b32 s45, 36, 28
  v_cmp_gt_u32 vcc, s45, v157
  s_nop 1
  v_cndmask_b32 v111, v7, v111, vcc
  s_cmp_eq_u32 s59, 0
  s_cselect_b32 s45, 4, 0
  v_cmp_gt_u32 vcc, s45, v157
  s_nop 1
  v_cndmask_b32 v156, v7, v156, vcc
  v_max_f32 v6, v99, v103
  v_max3_f32 v6, v6, v107, v111
  v_max_f32 v6, v6, v156
  s_nop 1
  v_max_f32_dpp v6, v6, v6 row_ror:8 row_mask:0xf bank_mask:0xf
  s_nop 1
  v_max_f32_dpp v6, v6, v6 row_ror:4 row_mask:0xf bank_mask:0xf
  s_nop 1
  v_max_f32_dpp v6, v6, v6 row_ror:2 row_mask:0xf bank_mask:0xf
  s_nop 1
  v_max_f32_dpp v6, v6, v6 row_ror:1 row_mask:0xf bank_mask:0xf
  s_nop 1
  v_max_f32_dpp v6, v6, v6 row_bcast:15 row_mask:0xa bank_mask:0xf
  s_nop 1
  v_max_f32_dpp v6, v6, v6 row_bcast:31 row_mask:0xc bank_mask:0xf
  s_nop 0
  v_readlane_b32 s55, v6, 63
  s_nop 1
  v_subrev_f32 v75, s55, v99
  v_subrev_f32 v79, s55, v103
  v_subrev_f32 v83, s55, v107
  v_subrev_f32 v87, s55, v111
  v_mul_f32 v75, s54, v75
  v_mul_f32 v79, s54, v79
  v_mul_f32 v83, s54, v83
  v_mul_f32 v87, s54, v87
  v_exp_f32 v75, v75
  v_exp_f32 v79, v79
  v_exp_f32 v83, v83
  v_exp_f32 v87, v87
  v_add_f32 v6, v75, v79
  v_add_f32 v7, v83, v87
  v_add_f32 v6, v6, v7
  v_subrev_f32 v91, s55, v156
  v_mul_f32 v91, s54, v91
  v_exp_f32 v91, v91
  s_nop 0
  v_add_f32 v6, v6, v91
  s_nop 1
  v_add_f32_dpp v6, v6, v6 row_ror:8 row_mask:0xf bank_mask:0xf
  s_nop 1
  v_add_f32_dpp v6, v6, v6 row_ror:4 row_mask:0xf bank_mask:0xf
  s_nop 1
  v_add_f32_dpp v6, v6, v6 row_ror:2 row_mask:0xf bank_mask:0xf
  s_nop 1
  v_add_f32_dpp v6, v6, v6 row_ror:1 row_mask:0xf bank_mask:0xf
  s_nop 1
  v_add_f32_dpp v6, v6, v6 row_bcast:15 row_mask:0xa bank_mask:0xf
  s_nop 1
  v_add_f32_dpp v6, v6, v6 row_bcast:31 row_mask:0xc bank_mask:0xf
  s_nop 0
  v_readlane_b32 s56, v6, 63
  s_lshl_b32 s45, s44, 3
  s_add_u32 s45, s45, 17408
  v_mov_b32 v91, s55
  v_mov_b32 v95, s56
  v_mov_b32 v6, s45
  ds_write_b32 v6, v91
  ds_write_b32 v6, v95 offset:4
  s_waitcnt lgkmcnt(0)
  s_barrier
  s_waitcnt vmcnt(11)
  buffer_load_dwordx3 v[72:74], v1, s[36:39], s46 offen nt
  s_addk_i32 s46, 6144
  s_waitcnt vmcnt(11)
  buffer_load_dwordx3 v[76:78], v1, s[36:39], s46 offen nt
  s_addk_i32 s46, 6144
  s_waitcnt vmcnt(11)
  buffer_load_dwordx3 v[80:82], v1, s[36:39], s46 offen nt
  s_addk_i32 s46, 6144
  s_waitcnt vmcnt(11)
  buffer_load_dwordx3 v[84:86], v1, s[36:39], s46 offen nt
  s_addk_i32 s46, 6144
  s_waitcnt vmcnt(11)
  buffer_load_dwordx3 v[88:90], v1, s[36:39], s46 offen nt
  s_addk_i32 s46, 6144
  s_waitcnt vmcnt(11)
  buffer_load_dwordx3 v[92:94], v1, s[36:39], s46 offen nt
  s_addk_i32 s46, 6144
  s_waitcnt vmcnt(11)
  buffer_load_dwordx3 v[96:98], v1, s[36:39], s46 offen nt
  s_addk_i32 s46, 6144
  s_waitcnt vmcnt(11)
  buffer_load_dwordx3 v[100:102], v1, s[36:39], s46 offen nt
  s_addk_i32 s46, 6144
  s_waitcnt vmcnt(11)
  buffer_load_dwordx3 v[104:106], v1, s[36:39], s46 offen nt
  s_addk_i32 s46, 6144
  s_waitcnt vmcnt(11)
  buffer_load_dwordx3 v[108:110], v1, s[36:39], s46 offen nt
  s_addk_i32 s46, 6144
  s_waitcnt vmcnt(11)
  buffer_load_dwordx3 v[112:114], v1, s[36:39], s46 offen nt
  s_addk_i32 s46, 6144
  s_waitcnt vmcnt(11)
  buffer_load_dwordx3 v[116:118], v1, s[36:39], s46 offen nt
  s_addk_i32 s46, 6144
  s_barrier
  v_mov_b32 v6, 17536
  ds_read_b64 v[164:165], v6
  s_waitcnt lgkmcnt(0)
  v_sub_f32 v75, v99, v164
  v_sub_f32 v79, v103, v164
  v_sub_f32 v83, v107, v164
  v_sub_f32 v87, v111, v164
  v_mul_f32 v75, s54, v75
  v_mul_f32 v79, s54, v79
  v_mul_f32 v83, s54, v83
  v_mul_f32 v87, s54, v87
  v_exp_f32 v75, v75
  v_exp_f32 v79, v79
  v_exp_f32 v83, v83
  v_exp_f32 v87, v87
  v_mul_f32 v75, v75, v165
  v_mul_f32 v79, v79, v165
  v_mul_f32 v83, v83, v165
  v_mul_f32 v87, v87, v165
  v_cvt_pk_bf16_f32 v91, v75, v79
  v_cvt_pk_bf16_f32 v95, v83, v87
  ds_write_b16 v71, v91
  ds_write_b16_d16_hi v71, v91 offset:64
  ds_write_b16 v71, v95 offset:128
  ds_write_b16_d16_hi v71, v95 offset:192
  v_sub_f32 v75, v156, v164
  v_mul_f32 v75, s54, v75
  v_exp_f32 v75, v75
  s_nop 0
  v_mul_f32 v75, v75, v165
  v_cvt_pk_bf16_f32 v91, v75, v75
  ds_write_b16 v71, v91 offset:256
  ds_read_b128 v[160:163], v67
  ds_read_b128 v[164:167], v67 offset:16
  s_waitcnt lgkmcnt(1)
  v_perm_b32 v139, v28, v24, s52
  v_perm_b32 v143, v28, v24, s53
  v_dot2c_f32_bf16 v115, v139, v160
  v_dot2c_f32_bf16 v119, v143, v160
  v_perm_b32 v147, v29, v25, s52
  v_perm_b32 v151, v29, v25, s53
  v_dot2c_f32_bf16 v123, v147, v160
  v_dot2c_f32_bf16 v127, v151, v160
  v_perm_b32 v139, v30, v26, s52
  v_perm_b32 v143, v30, v26, s53
  v_dot2c_f32_bf16 v131, v139, v160
  v_dot2c_f32_bf16 v135, v143, v160
  buffer_load_dwordx3 v[120:122], v1, s[36:39], s46 offen nt
  s_addk_i32 s46, 6144
  buffer_load_dwordx3 v[124:126], v1, s[36:39], s46 offen nt
  s_addk_i32 s46, 6144
  buffer_load_dwordx3 v[128:130], v1, s[36:39], s46 offen nt
  s_addk_i32 s46, 6144
  buffer_load_dwordx3 v[132:134], v1, s[36:39], s46 offen nt
  s_addk_i32 s46, 6144
  buffer_load_dwordx3 v[8:10], v1, s[36:39], s46 offen nt
  s_addk_i32 s46, 6144
  buffer_load_dwordx3 v[12:14], v1, s[36:39], s46 offen nt
  s_addk_i32 s46, 6144
  buffer_load_dwordx3 v[16:18], v1, s[36:39], s46 offen nt
  s_addk_i32 s46, 6144
  buffer_load_dwordx3 v[20:22], v1, s[36:39], s46 offen nt
  s_addk_i32 s46, 6144
  buffer_load_dwordx3 v[24:26], v1, s[36:39], s46 offen nt
  s_addk_i32 s46, 6144
  buffer_load_dwordx3 v[28:30], v1, s[36:39], s46 offen nt
  s_addk_i32 s46, 6144
  v_perm_b32 v139, v36, v32, s52
  v_perm_b32 v143, v36, v32, s53
  v_dot2c_f32_bf16 v115, v139, v161
  v_dot2c_f32_bf16 v119, v143, v161
  v_perm_b32 v147, v37, v33, s52
  v_perm_b32 v151, v37, v33, s53
  v_dot2c_f32_bf16 v123, v147, v161
  v_dot2c_f32_bf16 v127, v151, v161
  v_perm_b32 v139, v38, v34, s52
  v_perm_b32 v143, v38, v34, s53
  v_dot2c_f32_bf16 v131, v139, v161
  v_dot2c_f32_bf16 v135, v143, v161
  buffer_load_dwordx3 v[32:34], v1, s[36:39], s46 offen nt
  s_addk_i32 s46, 6144
  buffer_load_dwordx3 v[36:38], v1, s[36:39], s46 offen nt
  s_addk_i32 s46, 6144
  v_perm_b32 v139, v44, v40, s52
  v_perm_b32 v143, v44, v40, s53
  v_dot2c_f32_bf16 v115, v139, v162
  v_dot2c_f32_bf16 v119, v143, v162
  v_perm_b32 v147, v45, v41, s52
  v_perm_b32 v151, v45, v41, s53
  v_dot2c_f32_bf16 v123, v147, v162
  v_dot2c_f32_bf16 v127, v151, v162
  v_perm_b32 v139, v46, v42, s52
  v_perm_b32 v143, v46, v42, s53
  v_dot2c_f32_bf16 v131, v139, v162
  v_dot2c_f32_bf16 v135, v143, v162
  buffer_load_dwordx3 v[40:42], v1, s[36:39], s46 offen nt
  s_addk_i32 s46, 6144
  buffer_load_dwordx3 v[44:46], v1, s[36:39], s46 offen nt
  s_addk_i32 s46, 6144
  v_perm_b32 v139, v52, v48, s52
  v_perm_b32 v143, v52, v48, s53
  v_dot2c_f32_bf16 v115, v139, v163
  v_dot2c_f32_bf16 v119, v143, v163
  v_perm_b32 v147, v53, v49, s52
  v_perm_b32 v151, v53, v49, s53
  v_dot2c_f32_bf16 v123, v147, v163
  v_dot2c_f32_bf16 v127, v151, v163
  v_perm_b32 v139, v54, v50, s52
  v_perm_b32 v143, v54, v50, s53
  v_dot2c_f32_bf16 v131, v139, v163
  v_dot2c_f32_bf16 v135, v143, v163
  ds_read_b128 v[160:163], v67 offset:32
  buffer_load_dwordx3 v[48:50], v1, s[36:39], s46 offen nt
  s_addk_i32 s46, 6144
  buffer_load_dwordx3 v[52:54], v1, s[36:39], s46 offen nt
  s_addk_i32 s46, 6144
  s_waitcnt lgkmcnt(1)
  v_perm_b32 v139, v60, v56, s52
  v_perm_b32 v143, v60, v56, s53
  v_dot2c_f32_bf16 v115, v139, v164
  v_dot2c_f32_bf16 v119, v143, v164
  v_perm_b32 v147, v61, v57, s52
  v_perm_b32 v151, v61, v57, s53
  v_dot2c_f32_bf16 v123, v147, v164
  v_dot2c_f32_bf16 v127, v151, v164
  v_perm_b32 v139, v62, v58, s52
  v_perm_b32 v143, v62, v58, s53
  v_dot2c_f32_bf16 v131, v139, v164
  v_dot2c_f32_bf16 v135, v143, v164
  buffer_load_dwordx3 v[56:58], v1, s[36:39], s46 offen nt
  s_addk_i32 s46, 6144
  buffer_load_dwordx3 v[60:62], v1, s[36:39], s46 offen nt
  s_addk_i32 s46, 6144
  v_perm_b32 v139, v68, v64, s52
  v_perm_b32 v143, v68, v64, s53
  v_dot2c_f32_bf16 v115, v139, v165
  v_dot2c_f32_bf16 v119, v143, v165
  v_perm_b32 v147, v69, v65, s52
  v_perm_b32 v151, v69, v65, s53
  v_dot2c_f32_bf16 v123, v147, v165
  v_dot2c_f32_bf16 v127, v151, v165
  v_perm_b32 v139, v70, v66, s52
  v_perm_b32 v143, v70, v66, s53
  v_dot2c_f32_bf16 v131, v139, v165
  v_dot2c_f32_bf16 v135, v143, v165
  buffer_load_dwordx3 v[64:66], v1, s[36:39], s46 offen nt
  s_addk_i32 s46, 6144
  buffer_load_dwordx3 v[68:70], v1, s[36:39], s46 offen nt
  s_addk_i32 s46, 6144
  s_waitcnt vmcnt(30)
  v_perm_b32 v139, v76, v72, s52
  v_perm_b32 v143, v76, v72, s53
  v_dot2c_f32_bf16 v115, v139, v166
  v_dot2c_f32_bf16 v119, v143, v166
  v_perm_b32 v147, v77, v73, s52
  v_perm_b32 v151, v77, v73, s53
  v_dot2c_f32_bf16 v123, v147, v166
  v_dot2c_f32_bf16 v127, v151, v166
  v_perm_b32 v139, v78, v74, s52
  v_perm_b32 v143, v78, v74, s53
  v_dot2c_f32_bf16 v131, v139, v166
  v_dot2c_f32_bf16 v135, v143, v166
  buffer_load_dwordx3 v[72:74], v1, s[36:39], s46 offen nt
  s_addk_i32 s46, 6144
  buffer_load_dwordx3 v[76:78], v1, s[36:39], s46 offen nt
  s_addk_i32 s46, 6144
  s_waitcnt vmcnt(30)
  v_perm_b32 v139, v84, v80, s52
  v_perm_b32 v143, v84, v80, s53
  v_dot2c_f32_bf16 v115, v139, v167
  v_dot2c_f32_bf16 v119, v143, v167
  v_perm_b32 v147, v85, v81, s52
  v_perm_b32 v151, v85, v81, s53
  v_dot2c_f32_bf16 v123, v147, v167
  v_dot2c_f32_bf16 v127, v151, v167
  v_perm_b32 v139, v86, v82, s52
  v_perm_b32 v143, v86, v82, s53
  v_dot2c_f32_bf16 v131, v139, v167
  v_dot2c_f32_bf16 v135, v143, v167
  ds_read_b128 v[164:167], v67 offset:48
  buffer_load_dwordx3 v[80:82], v1, s[36:39], s46 offen nt
  s_addk_i32 s46, 6144
  buffer_load_dwordx3 v[84:86], v1, s[36:39], s46 offen nt
  s_addk_i32 s46, 6144
  s_waitcnt lgkmcnt(1)
  s_waitcnt vmcnt(30)
  v_perm_b32 v139, v92, v88, s52
  v_perm_b32 v143, v92, v88, s53
  v_dot2c_f32_bf16 v115, v139, v160
  v_dot2c_f32_bf16 v119, v143, v160
  v_perm_b32 v147, v93, v89, s52
  v_perm_b32 v151, v93, v89, s53
  v_dot2c_f32_bf16 v123, v147, v160
  v_dot2c_f32_bf16 v127, v151, v160
  v_perm_b32 v139, v94, v90, s52
  v_perm_b32 v143, v94, v90, s53
  v_dot2c_f32_bf16 v131, v139, v160
  v_dot2c_f32_bf16 v135, v143, v160
  buffer_load_dwordx3 v[88:90], v1, s[36:39], s46 offen nt
  s_addk_i32 s46, 6144
  buffer_load_dwordx3 v[92:94], v1, s[36:39], s46 offen nt
  s_addk_i32 s46, 6144
  s_waitcnt vmcnt(30)
  v_perm_b32 v139, v100, v96, s52
  v_perm_b32 v143, v100, v96, s53
  v_dot2c_f32_bf16 v115, v139, v161
  v_dot2c_f32_bf16 v119, v143, v161
  v_perm_b32 v147, v101, v97, s52
  v_perm_b32 v151, v101, v97, s53
  v_dot2c_f32_bf16 v123, v147, v161
  v_dot2c_f32_bf16 v127, v151, v161
  v_perm_b32 v139, v102, v98, s52
  v_perm_b32 v143, v102, v98, s53
  v_dot2c_f32_bf16 v131, v139, v161
  v_dot2c_f32_bf16 v135, v143, v161
  buffer_load_dwordx3 v[96:98], v1, s[36:39], s46 offen nt
  s_addk_i32 s46, 6144
  buffer_load_dwordx3 v[100:102], v1, s[36:39], s46 offen nt
  s_addk_i32 s46, 6144
  s_waitcnt vmcnt(30)
  v_perm_b32 v139, v108, v104, s52
  v_perm_b32 v143, v108, v104, s53
  v_dot2c_f32_bf16 v115, v139, v162
  v_dot2c_f32_bf16 v119, v143, v162
  v_perm_b32 v147, v109, v105, s52
  v_perm_b32 v151, v109, v105, s53
  v_dot2c_f32_bf16 v123, v147, v162
  v_dot2c_f32_bf16 v127, v151, v162
  v_perm_b32 v139, v110, v106, s52
  v_perm_b32 v143, v110, v106, s53
  v_dot2c_f32_bf16 v131, v139, v162
  v_dot2c_f32_bf16 v135, v143, v162
  buffer_load_dwordx3 v[104:106], v1, s[36:39], s46 offen nt
  s_addk_i32 s46, 6144
  buffer_load_dwordx3 v[108:110], v1, s[36:39], s46 offen nt
  s_addk_i32 s46, 6144
  s_waitcnt vmcnt(30)
  v_perm_b32 v139, v116, v112, s52
  v_perm_b32 v143, v116, v112, s53
  v_dot2c_f32_bf16 v115, v139, v163
  v_dot2c_f32_bf16 v119, v143, v163
  v_perm_b32 v147, v117, v113, s52
  v_perm_b32 v151, v117, v113, s53
  v_dot2c_f32_bf16 v123, v147, v163
  v_dot2c_f32_bf16 v127, v151, v163
  v_perm_b32 v139, v118, v114, s52
  v_perm_b32 v143, v118, v114, s53
  v_dot2c_f32_bf16 v131, v139, v163
  v_dot2c_f32_bf16 v135, v143, v163
  ds_read_b128 v[160:163], v67 offset:64
  buffer_load_dwordx3 v[112:114], v1, s[36:39], s46 offen nt
  s_addk_i32 s46, 6144
  buffer_load_dwordx3 v[116:118], v1, s[36:39], s46 offen nt
  s_addk_i32 s46, 6144
  s_waitcnt lgkmcnt(1)
  s_waitcnt vmcnt(30)
  v_perm_b32 v139, v124, v120, s52
  v_perm_b32 v143, v124, v120, s53
  v_dot2c_f32_bf16 v115, v139, v164
  v_dot2c_f32_bf16 v119, v143, v164
  v_perm_b32 v147, v125, v121, s52
  v_perm_b32 v151, v125, v121, s53
  v_dot2c_f32_bf16 v123, v147, v164
  v_dot2c_f32_bf16 v127, v151, v164
  v_perm_b32 v139, v126, v122, s52
  v_perm_b32 v143, v126, v122, s53
  v_dot2c_f32_bf16 v131, v139, v164
  v_dot2c_f32_bf16 v135, v143, v164
  buffer_load_dwordx3 v[120:122], v1, s[36:39], s46 offen nt
  s_addk_i32 s46, 6144
  buffer_load_dwordx3 v[124:126], v1, s[36:39], s46 offen nt
  s_addk_i32 s46, 6144
  s_waitcnt vmcnt(30)
  v_perm_b32 v139, v132, v128, s52
  v_perm_b32 v143, v132, v128, s53
  v_dot2c_f32_bf16 v115, v139, v165
  v_dot2c_f32_bf16 v119, v143, v165
  v_perm_b32 v147, v133, v129, s52
  v_perm_b32 v151, v133, v129, s53
  v_dot2c_f32_bf16 v123, v147, v165
  v_dot2c_f32_bf16 v127, v151, v165
  v_perm_b32 v139, v134, v130, s52
  v_perm_b32 v143, v134, v130, s53
  v_dot2c_f32_bf16 v131, v139, v165
  v_dot2c_f32_bf16 v135, v143, v165
  buffer_load_dwordx3 v[128:130], v1, s[36:39], s46 offen nt
  s_addk_i32 s46, 6144
  buffer_load_dwordx3 v[132:134], v1, s[36:39], s46 offen nt
  s_addk_i32 s46, 6144
  s_waitcnt vmcnt(30)
  v_perm_b32 v139, v12, v8, s52
  v_perm_b32 v143, v12, v8, s53
  v_dot2c_f32_bf16 v115, v139, v166
  v_dot2c_f32_bf16 v119, v143, v166
  v_perm_b32 v147, v13, v9, s52
  v_perm_b32 v151, v13, v9, s53
  v_dot2c_f32_bf16 v123, v147, v166
  v_dot2c_f32_bf16 v127, v151, v166
  v_perm_b32 v139, v14, v10, s52
  v_perm_b32 v143, v14, v10, s53
  v_dot2c_f32_bf16 v131, v139, v166
  v_dot2c_f32_bf16 v135, v143, v166
  buffer_load_dwordx3 v[8:10], v1, s[36:39], s46 offen nt
  s_addk_i32 s46, 6144
  buffer_load_dwordx3 v[12:14], v1, s[36:39], s46 offen nt
  s_addk_i32 s46, 6144
  s_waitcnt vmcnt(30)
  v_perm_b32 v139, v20, v16, s52
  v_perm_b32 v143, v20, v16, s53
  v_dot2c_f32_bf16 v115, v139, v167
  v_dot2c_f32_bf16 v119, v143, v167
  v_perm_b32 v147, v21, v17, s52
  v_perm_b32 v151, v21, v17, s53
  v_dot2c_f32_bf16 v123, v147, v167
  v_dot2c_f32_bf16 v127, v151, v167
  v_perm_b32 v139, v22, v18, s52
  v_perm_b32 v143, v22, v18, s53
  v_dot2c_f32_bf16 v131, v139, v167
  v_dot2c_f32_bf16 v135, v143, v167
  ds_read_b128 v[164:167], v67 offset:80
  buffer_load_dwordx3 v[16:18], v1, s[36:39], s46 offen nt
  s_addk_i32 s46, 6144
  buffer_load_dwordx3 v[20:22], v1, s[36:39], s46 offen nt
  s_addk_i32 s46, 6144
  s_waitcnt lgkmcnt(1)
  s_waitcnt vmcnt(30)
  v_perm_b32 v139, v28, v24, s52
  v_perm_b32 v143, v28, v24, s53
  v_dot2c_f32_bf16 v115, v139, v160
  v_dot2c_f32_bf16 v119, v143, v160
  v_perm_b32 v147, v29, v25, s52
  v_perm_b32 v151, v29, v25, s53
  v_dot2c_f32_bf16 v123, v147, v160
  v_dot2c_f32_bf16 v127, v151, v160
  v_perm_b32 v139, v30, v26, s52
  v_perm_b32 v143, v30, v26, s53
  v_dot2c_f32_bf16 v131, v139, v160
  v_dot2c_f32_bf16 v135, v143, v160
  buffer_load_dwordx3 v[24:26], v1, s[36:39], s46 offen nt
  s_addk_i32 s46, 6144
  buffer_load_dwordx3 v[28:30], v1, s[36:39], s46 offen nt
  s_addk_i32 s46, 6144
  s_waitcnt vmcnt(30)
  v_perm_b32 v139, v36, v32, s52
  v_perm_b32 v143, v36, v32, s53
  v_dot2c_f32_bf16 v115, v139, v161
  v_dot2c_f32_bf16 v119, v143, v161
  v_perm_b32 v147, v37, v33, s52
  v_perm_b32 v151, v37, v33, s53
  v_dot2c_f32_bf16 v123, v147, v161
  v_dot2c_f32_bf16 v127, v151, v161
  v_perm_b32 v139, v38, v34, s52
  v_perm_b32 v143, v38, v34, s53
  v_dot2c_f32_bf16 v131, v139, v161
  v_dot2c_f32_bf16 v135, v143, v161
  buffer_load_dwordx3 v[32:34], v1, s[36:39], s46 offen nt
  s_addk_i32 s46, 6144
  buffer_load_dwordx3 v[36:38], v1, s[36:39], s46 offen nt
  s_addk_i32 s46, 6144
  s_waitcnt vmcnt(30)
  v_perm_b32 v139, v44, v40, s52
  v_perm_b32 v143, v44, v40, s53
  v_dot2c_f32_bf16 v115, v139, v162
  v_dot2c_f32_bf16 v119, v143, v162
  v_perm_b32 v147, v45, v41, s52
  v_perm_b32 v151, v45, v41, s53
  v_dot2c_f32_bf16 v123, v147, v162
  v_dot2c_f32_bf16 v127, v151, v162
  v_perm_b32 v139, v46, v42, s52
  v_perm_b32 v143, v46, v42, s53
  v_dot2c_f32_bf16 v131, v139, v162
  v_dot2c_f32_bf16 v135, v143, v162
  buffer_load_dwordx3 v[40:42], v1, s[36:39], s46 offen nt
  s_addk_i32 s46, 6144
  buffer_load_dwordx3 v[44:46], v1, s[36:39], s46 offen nt
  s_addk_i32 s46, 6144
  s_waitcnt vmcnt(30)
  v_perm_b32 v139, v52, v48, s52
  v_perm_b32 v143, v52, v48, s53
  v_dot2c_f32_bf16 v115, v139, v163
  v_dot2c_f32_bf16 v119, v143, v163
  v_perm_b32 v147, v53, v49, s52
  v_perm_b32 v151, v53, v49, s53
  v_dot2c_f32_bf16 v123, v147, v163
  v_dot2c_f32_bf16 v127, v151, v163
  v_perm_b32 v139, v54, v50, s52
  v_perm_b32 v143, v54, v50, s53
  v_dot2c_f32_bf16 v131, v139, v163
  v_dot2c_f32_bf16 v135, v143, v163
  ds_read_b128 v[160:163], v67 offset:96
  buffer_load_dwordx3 v[48:50], v1, s[36:39], s46 offen nt
  s_addk_i32 s46, 6144
  buffer_load_dwordx3 v[52:54], v1, s[36:39], s46 offen nt
  s_addk_i32 s46, 6144
  s_waitcnt lgkmcnt(1)
  s_waitcnt vmcnt(30)
  v_perm_b32 v139, v60, v56, s52
  v_perm_b32 v143, v60, v56, s53
  v_dot2c_f32_bf16 v115, v139, v164
  v_dot2c_f32_bf16 v119, v143, v164
  v_perm_b32 v147, v61, v57, s52
  v_perm_b32 v151, v61, v57, s53
  v_dot2c_f32_bf16 v123, v147, v164
  v_dot2c_f32_bf16 v127, v151, v164
  v_perm_b32 v139, v62, v58, s52
  v_perm_b32 v143, v62, v58, s53
  v_dot2c_f32_bf16 v131, v139, v164
  v_dot2c_f32_bf16 v135, v143, v164
  buffer_load_dwordx3 v[56:58], v1, s[36:39], s46 offen nt
  s_addk_i32 s46, 6144
  buffer_load_dwordx3 v[60:62], v1, s[36:39], s46 offen nt
  s_addk_i32 s46, 6144
  s_waitcnt vmcnt(30)
  v_perm_b32 v139, v68, v64, s52
  v_perm_b32 v143, v68, v64, s53
  v_dot2c_f32_bf16 v115, v139, v165
  v_dot2c_f32_bf16 v119, v143, v165
  v_perm_b32 v147, v69, v65, s52
  v_perm_b32 v151, v69, v65, s53
  v_dot2c_f32_bf16 v123, v147, v165
  v_dot2c_f32_bf16 v127, v151, v165
  v_perm_b32 v139, v70, v66, s52
  v_perm_b32 v143, v70, v66, s53
  v_dot2c_f32_bf16 v131, v139, v165
  v_dot2c_f32_bf16 v135, v143, v165
  buffer_load_dwordx3 v[64:66], v1, s[36:39], s46 offen nt
  s_addk_i32 s46, 6144
  buffer_load_dwordx3 v[68:70], v1, s[36:39], s46 offen nt
  s_addk_i32 s46, 6144
  s_waitcnt vmcnt(30)
  v_perm_b32 v139, v76, v72, s52
  v_perm_b32 v143, v76, v72, s53
  v_dot2c_f32_bf16 v115, v139, v166
  v_dot2c_f32_bf16 v119, v143, v166
  v_perm_b32 v147, v77, v73, s52
  v_perm_b32 v151, v77, v73, s53
  v_dot2c_f32_bf16 v123, v147, v166
  v_dot2c_f32_bf16 v127, v151, v166
  v_perm_b32 v139, v78, v74, s52
  v_perm_b32 v143, v78, v74, s53
  v_dot2c_f32_bf16 v131, v139, v166
  v_dot2c_f32_bf16 v135, v143, v166
  buffer_load_dwordx3 v[72:74], v1, s[36:39], s46 offen nt
  s_addk_i32 s46, 6144
  buffer_load_dwordx3 v[76:78], v1, s[36:39], s46 offen nt
  s_addk_i32 s46, 6144
  s_waitcnt vmcnt(30)
  v_perm_b32 v139, v84, v80, s52
  v_perm_b32 v143, v84, v80, s53
  v_dot2c_f32_bf16 v115, v139, v167
  v_dot2c_f32_bf16 v119, v143, v167
  v_perm_b32 v147, v85, v81, s52
  v_perm_b32 v151, v85, v81, s53
  v_dot2c_f32_bf16 v123, v147, v167
  v_dot2c_f32_bf16 v127, v151, v167
  v_perm_b32 v139, v86, v82, s52
  v_perm_b32 v143, v86, v82, s53
  v_dot2c_f32_bf16 v131, v139, v167
  v_dot2c_f32_bf16 v135, v143, v167
  ds_read_b128 v[164:167], v67 offset:112
  buffer_load_dwordx3 v[80:82], v1, s[36:39], s46 offen nt
  s_addk_i32 s46, 6144
  buffer_load_dwordx3 v[84:86], v1, s[36:39], s46 offen nt
  s_addk_i32 s46, 6144
  s_waitcnt lgkmcnt(1)
  s_waitcnt vmcnt(30)
  v_perm_b32 v139, v92, v88, s52
  v_perm_b32 v143, v92, v88, s53
  v_dot2c_f32_bf16 v115, v139, v160
  v_dot2c_f32_bf16 v119, v143, v160
  v_perm_b32 v147, v93, v89, s52
  v_perm_b32 v151, v93, v89, s53
  v_dot2c_f32_bf16 v123, v147, v160
  v_dot2c_f32_bf16 v127, v151, v160
  v_perm_b32 v139, v94, v90, s52
  v_perm_b32 v143, v94, v90, s53
  v_dot2c_f32_bf16 v131, v139, v160
  v_dot2c_f32_bf16 v135, v143, v160
  buffer_load_dwordx3 v[88:90], v1, s[36:39], s46 offen nt
  s_addk_i32 s46, 6144
  buffer_load_dwordx3 v[92:94], v1, s[36:39], s46 offen nt
  s_addk_i32 s46, 6144
  s_waitcnt vmcnt(30)
  v_perm_b32 v139, v100, v96, s52
  v_perm_b32 v143, v100, v96, s53
  v_dot2c_f32_bf16 v115, v139, v161
  v_dot2c_f32_bf16 v119, v143, v161
  v_perm_b32 v147, v101, v97, s52
  v_perm_b32 v151, v101, v97, s53
  v_dot2c_f32_bf16 v123, v147, v161
  v_dot2c_f32_bf16 v127, v151, v161
  v_perm_b32 v139, v102, v98, s52
  v_perm_b32 v143, v102, v98, s53
  v_dot2c_f32_bf16 v131, v139, v161
  v_dot2c_f32_bf16 v135, v143, v161
  buffer_load_dwordx3 v[96:98], v1, s[36:39], s46 offen nt
  s_addk_i32 s46, 6144
  buffer_load_dwordx3 v[100:102], v1, s[36:39], s46 offen nt
  s_addk_i32 s46, 6144
  s_waitcnt vmcnt(30)
  v_perm_b32 v139, v108, v104, s52
  v_perm_b32 v143, v108, v104, s53
  v_dot2c_f32_bf16 v115, v139, v162
  v_dot2c_f32_bf16 v119, v143, v162
  v_perm_b32 v147, v109, v105, s52
  v_perm_b32 v151, v109, v105, s53
  v_dot2c_f32_bf16 v123, v147, v162
  v_dot2c_f32_bf16 v127, v151, v162
  v_perm_b32 v139, v110, v106, s52
  v_perm_b32 v143, v110, v106, s53
  v_dot2c_f32_bf16 v131, v139, v162
  v_dot2c_f32_bf16 v135, v143, v162
  buffer_load_dwordx3 v[104:106], v1, s[36:39], s46 offen nt
  s_addk_i32 s46, 6144
  buffer_load_dwordx3 v[108:110], v1, s[36:39], s46 offen nt
  s_addk_i32 s46, 6144
  s_waitcnt vmcnt(30)
  v_perm_b32 v139, v116, v112, s52
  v_perm_b32 v143, v116, v112, s53
  v_dot2c_f32_bf16 v115, v139, v163
  v_dot2c_f32_bf16 v119, v143, v163
  v_perm_b32 v147, v117, v113, s52
  v_perm_b32 v151, v117, v113, s53
  v_dot2c_f32_bf16 v123, v147, v163
  v_dot2c_f32_bf16 v127, v151, v163
  v_perm_b32 v139, v118, v114, s52
  v_perm_b32 v143, v118, v114, s53
  v_dot2c_f32_bf16 v131, v139, v163
  v_dot2c_f32_bf16 v135, v143, v163
  ds_read_b128 v[160:163], v67 offset:128
  buffer_load_dwordx3 v[112:114], v1, s[36:39], s46 offen nt
  s_addk_i32 s46, 6144
  buffer_load_dwordx3 v[116:118], v1, s[36:39], s46 offen nt
  s_addk_i32 s46, 6144
  s_waitcnt lgkmcnt(1)
  s_waitcnt vmcnt(30)
  v_perm_b32 v139, v124, v120, s52
  v_perm_b32 v143, v124, v120, s53
  v_dot2c_f32_bf16 v115, v139, v164
  v_dot2c_f32_bf16 v119, v143, v164
  v_perm_b32 v147, v125, v121, s52
  v_perm_b32 v151, v125, v121, s53
  v_dot2c_f32_bf16 v123, v147, v164
  v_dot2c_f32_bf16 v127, v151, v164
  v_perm_b32 v139, v126, v122, s52
  v_perm_b32 v143, v126, v122, s53
  v_dot2c_f32_bf16 v131, v139, v164
  v_dot2c_f32_bf16 v135, v143, v164
  buffer_load_dwordx3 v[120:122], v1, s[36:39], s46 offen nt
  s_addk_i32 s46, 6144
  buffer_load_dwordx3 v[124:126], v1, s[36:39], s46 offen nt
  s_addk_i32 s46, 6144
  s_waitcnt vmcnt(30)
  v_perm_b32 v139, v132, v128, s52
  v_perm_b32 v143, v132, v128, s53
  v_dot2c_f32_bf16 v115, v139, v165
  v_dot2c_f32_bf16 v119, v143, v165
  v_perm_b32 v147, v133, v129, s52
  v_perm_b32 v151, v133, v129, s53
  v_dot2c_f32_bf16 v123, v147, v165
  v_dot2c_f32_bf16 v127, v151, v165
  v_perm_b32 v139, v134, v130, s52
  v_perm_b32 v143, v134, v130, s53
  v_dot2c_f32_bf16 v131, v139, v165
  v_dot2c_f32_bf16 v135, v143, v165
  buffer_load_dwordx3 v[128:130], v1, s[36:39], s46 offen nt
  s_addk_i32 s46, 6144
  buffer_load_dwordx3 v[132:134], v1, s[36:39], s46 offen nt
  s_addk_i32 s46, 6144
  s_waitcnt vmcnt(30)
  v_perm_b32 v139, v12, v8, s52
  v_perm_b32 v143, v12, v8, s53
  v_dot2c_f32_bf16 v115, v139, v166
  v_dot2c_f32_bf16 v119, v143, v166
  v_perm_b32 v147, v13, v9, s52
  v_perm_b32 v151, v13, v9, s53
  v_dot2c_f32_bf16 v123, v147, v166
  v_dot2c_f32_bf16 v127, v151, v166
  v_perm_b32 v139, v14, v10, s52
  v_perm_b32 v143, v14, v10, s53
  v_dot2c_f32_bf16 v131, v139, v166
  v_dot2c_f32_bf16 v135, v143, v166
  buffer_load_dwordx3 v[8:10], v1, s[36:39], s46 offen nt
  s_addk_i32 s46, 6144
  buffer_load_dwordx3 v[12:14], v1, s[36:39], s46 offen nt
  s_addk_i32 s46, 6144
  s_waitcnt vmcnt(30)
  v_perm_b32 v139, v20, v16, s52
  v_perm_b32 v143, v20, v16, s53
  v_dot2c_f32_bf16 v115, v139, v167
  v_dot2c_f32_bf16 v119, v143, v167
  v_perm_b32 v147, v21, v17, s52
  v_perm_b32 v151, v21, v17, s53
  v_dot2c_f32_bf16 v123, v147, v167
  v_dot2c_f32_bf16 v127, v151, v167
  v_perm_b32 v139, v22, v18, s52
  v_perm_b32 v143, v22, v18, s53
  v_dot2c_f32_bf16 v131, v139, v167
  v_dot2c_f32_bf16 v135, v143, v167
  ds_read_b128 v[164:167], v67 offset:144
  buffer_load_dwordx3 v[16:18], v1, s[36:39], s46 offen nt
  s_addk_i32 s46, 6144
  buffer_load_dwordx3 v[20:22], v1, s[36:39], s46 offen nt
  s_addk_i32 s46, 6144
  s_waitcnt lgkmcnt(1)
  s_waitcnt vmcnt(30)
  v_perm_b32 v139, v28, v24, s52
  v_perm_b32 v143, v28, v24, s53
  v_dot2c_f32_bf16 v115, v139, v160
  v_dot2c_f32_bf16 v119, v143, v160
  v_perm_b32 v147, v29, v25, s52
  v_perm_b32 v151, v29, v25, s53
  v_dot2c_f32_bf16 v123, v147, v160
  v_dot2c_f32_bf16 v127, v151, v160
  v_perm_b32 v139, v30, v26, s52
  v_perm_b32 v143, v30, v26, s53
  v_dot2c_f32_bf16 v131, v139, v160
  v_dot2c_f32_bf16 v135, v143, v160
  buffer_load_dwordx3 v[24:26], v1, s[36:39], s46 offen nt
  s_addk_i32 s46, 6144
  buffer_load_dwordx3 v[28:30], v1, s[36:39], s46 offen nt
  s_addk_i32 s46, 6144
  s_waitcnt vmcnt(30)
  v_perm_b32 v139, v36, v32, s52
  v_perm_b32 v143, v36, v32, s53
  v_dot2c_f32_bf16 v115, v139, v161
  v_dot2c_f32_bf16 v119, v143, v161
  v_perm_b32 v147, v37, v33, s52
  v_perm_b32 v151, v37, v33, s53
  v_dot2c_f32_bf16 v123, v147, v161
  v_dot2c_f32_bf16 v127, v151, v161
  v_perm_b32 v139, v38, v34, s52
  v_perm_b32 v143, v38, v34, s53
  v_dot2c_f32_bf16 v131, v139, v161
  v_dot2c_f32_bf16 v135, v143, v161
  buffer_load_dwordx3 v[32:34], v1, s[36:39], s46 offen nt
  s_addk_i32 s46, 6144
  buffer_load_dwordx3 v[36:38], v1, s[36:39], s46 offen nt
  s_addk_i32 s46, 6144
  s_waitcnt vmcnt(30)
  v_perm_b32 v139, v44, v40, s52
  v_perm_b32 v143, v44, v40, s53
  v_dot2c_f32_bf16 v115, v139, v162
  v_dot2c_f32_bf16 v119, v143, v162
  v_perm_b32 v147, v45, v41, s52
  v_perm_b32 v151, v45, v41, s53
  v_dot2c_f32_bf16 v123, v147, v162
  v_dot2c_f32_bf16 v127, v151, v162
  v_perm_b32 v139, v46, v42, s52
  v_perm_b32 v143, v46, v42, s53
  v_dot2c_f32_bf16 v131, v139, v162
  v_dot2c_f32_bf16 v135, v143, v162
  buffer_load_dwordx3 v[40:42], v1, s[36:39], s46 offen nt
  s_addk_i32 s46, 6144
  buffer_load_dwordx3 v[44:46], v1, s[36:39], s46 offen nt
  s_addk_i32 s46, 6144
  s_waitcnt vmcnt(30)
  v_perm_b32 v139, v52, v48, s52
  v_perm_b32 v143, v52, v48, s53
  v_dot2c_f32_bf16 v115, v139, v163
  v_dot2c_f32_bf16 v119, v143, v163
  v_perm_b32 v147, v53, v49, s52
  v_perm_b32 v151, v53, v49, s53
  v_dot2c_f32_bf16 v123, v147, v163
  v_dot2c_f32_bf16 v127, v151, v163
  v_perm_b32 v139, v54, v50, s52
  v_perm_b32 v143, v54, v50, s53
  v_dot2c_f32_bf16 v131, v139, v163
  v_dot2c_f32_bf16 v135, v143, v163
  ds_read_b128 v[160:163], v67 offset:160
  buffer_load_dwordx3 v[48:50], v1, s[36:39], s46 offen nt
  s_addk_i32 s46, 6144
  buffer_load_dwordx3 v[52:54], v1, s[36:39], s46 offen nt
  s_addk_i32 s46, 6144
  s_waitcnt lgkmcnt(1)
  s_waitcnt vmcnt(30)
  v_perm_b32 v139, v60, v56, s52
  v_perm_b32 v143, v60, v56, s53
  v_dot2c_f32_bf16 v115, v139, v164
  v_dot2c_f32_bf16 v119, v143, v164
  v_perm_b32 v147, v61, v57, s52
  v_perm_b32 v151, v61, v57, s53
  v_dot2c_f32_bf16 v123, v147, v164
  v_dot2c_f32_bf16 v127, v151, v164
  v_perm_b32 v139, v62, v58, s52
  v_perm_b32 v143, v62, v58, s53
  v_dot2c_f32_bf16 v131, v139, v164
  v_dot2c_f32_bf16 v135, v143, v164
  buffer_load_dwordx3 v[56:58], v1, s[36:39], s46 offen nt
  s_addk_i32 s46, 6144
  buffer_load_dwordx3 v[60:62], v1, s[36:39], s46 offen nt
  s_addk_i32 s46, 6144
  s_waitcnt vmcnt(30)
  v_perm_b32 v139, v68, v64, s52
  v_perm_b32 v143, v68, v64, s53
  v_dot2c_f32_bf16 v115, v139, v165
  v_dot2c_f32_bf16 v119, v143, v165
  v_perm_b32 v147, v69, v65, s52
  v_perm_b32 v151, v69, v65, s53
  v_dot2c_f32_bf16 v123, v147, v165
  v_dot2c_f32_bf16 v127, v151, v165
  v_perm_b32 v139, v70, v66, s52
  v_perm_b32 v143, v70, v66, s53
  v_dot2c_f32_bf16 v131, v139, v165
  v_dot2c_f32_bf16 v135, v143, v165
  buffer_load_dwordx3 v[64:66], v1, s[36:39], s46 offen nt
  s_addk_i32 s46, 6144
  buffer_load_dwordx3 v[68:70], v1, s[36:39], s46 offen nt
  s_addk_i32 s46, 6144
  s_waitcnt vmcnt(30)
  v_perm_b32 v139, v76, v72, s52
  v_perm_b32 v143, v76, v72, s53
  v_dot2c_f32_bf16 v115, v139, v166
  v_dot2c_f32_bf16 v119, v143, v166
  v_perm_b32 v147, v77, v73, s52
  v_perm_b32 v151, v77, v73, s53
  v_dot2c_f32_bf16 v123, v147, v166
  v_dot2c_f32_bf16 v127, v151, v166
  v_perm_b32 v139, v78, v74, s52
  v_perm_b32 v143, v78, v74, s53
  v_dot2c_f32_bf16 v131, v139, v166
  v_dot2c_f32_bf16 v135, v143, v166
  buffer_load_dwordx3 v[72:74], v1, s[36:39], s46 offen nt
  s_addk_i32 s46, 6144
  buffer_load_dwordx3 v[76:78], v1, s[36:39], s46 offen nt
  s_addk_i32 s46, 6144
  s_waitcnt vmcnt(30)
  v_perm_b32 v139, v84, v80, s52
  v_perm_b32 v143, v84, v80, s53
  v_dot2c_f32_bf16 v115, v139, v167
  v_dot2c_f32_bf16 v119, v143, v167
  v_perm_b32 v147, v85, v81, s52
  v_perm_b32 v151, v85, v81, s53
  v_dot2c_f32_bf16 v123, v147, v167
  v_dot2c_f32_bf16 v127, v151, v167
  v_perm_b32 v139, v86, v82, s52
  v_perm_b32 v143, v86, v82, s53
  v_dot2c_f32_bf16 v131, v139, v167
  v_dot2c_f32_bf16 v135, v143, v167
  ds_read_b128 v[164:167], v67 offset:176
  buffer_load_dwordx3 v[80:82], v1, s[36:39], s46 offen nt
  s_addk_i32 s46, 6144
  buffer_load_dwordx3 v[84:86], v1, s[36:39], s46 offen nt
  s_addk_i32 s46, 6144
  s_waitcnt lgkmcnt(1)
  s_waitcnt vmcnt(30)
  v_perm_b32 v139, v92, v88, s52
  v_perm_b32 v143, v92, v88, s53
  v_dot2c_f32_bf16 v115, v139, v160
  v_dot2c_f32_bf16 v119, v143, v160
  v_perm_b32 v147, v93, v89, s52
  v_perm_b32 v151, v93, v89, s53
  v_dot2c_f32_bf16 v123, v147, v160
  v_dot2c_f32_bf16 v127, v151, v160
  v_perm_b32 v139, v94, v90, s52
  v_perm_b32 v143, v94, v90, s53
  v_dot2c_f32_bf16 v131, v139, v160
  v_dot2c_f32_bf16 v135, v143, v160
  buffer_load_dwordx3 v[88:90], v1, s[36:39], s46 offen nt
  s_addk_i32 s46, 6144
  buffer_load_dwordx3 v[92:94], v1, s[36:39], s46 offen nt
  s_addk_i32 s46, 6144
  s_waitcnt vmcnt(30)
  v_perm_b32 v139, v100, v96, s52
  v_perm_b32 v143, v100, v96, s53
  v_dot2c_f32_bf16 v115, v139, v161
  v_dot2c_f32_bf16 v119, v143, v161
  v_perm_b32 v147, v101, v97, s52
  v_perm_b32 v151, v101, v97, s53
  v_dot2c_f32_bf16 v123, v147, v161
  v_dot2c_f32_bf16 v127, v151, v161
  v_perm_b32 v139, v102, v98, s52
  v_perm_b32 v143, v102, v98, s53
  v_dot2c_f32_bf16 v131, v139, v161
  v_dot2c_f32_bf16 v135, v143, v161
  buffer_load_dwordx3 v[96:98], v1, s[36:39], s46 offen nt
  s_addk_i32 s46, 6144
  buffer_load_dwordx3 v[100:102], v1, s[36:39], s46 offen nt
  s_addk_i32 s46, 6144
  s_waitcnt vmcnt(30)
  v_perm_b32 v139, v108, v104, s52
  v_perm_b32 v143, v108, v104, s53
  v_dot2c_f32_bf16 v115, v139, v162
  v_dot2c_f32_bf16 v119, v143, v162
  v_perm_b32 v147, v109, v105, s52
  v_perm_b32 v151, v109, v105, s53
  v_dot2c_f32_bf16 v123, v147, v162
  v_dot2c_f32_bf16 v127, v151, v162
  v_perm_b32 v139, v110, v106, s52
  v_perm_b32 v143, v110, v106, s53
  v_dot2c_f32_bf16 v131, v139, v162
  v_dot2c_f32_bf16 v135, v143, v162
  buffer_load_dwordx3 v[104:106], v1, s[36:39], s46 offen nt
  s_addk_i32 s46, 6144
  buffer_load_dwordx3 v[108:110], v1, s[36:39], s46 offen nt
  s_addk_i32 s46, 6144
  s_waitcnt vmcnt(30)
  v_perm_b32 v139, v116, v112, s52
  v_perm_b32 v143, v116, v112, s53
  v_dot2c_f32_bf16 v115, v139, v163
  v_dot2c_f32_bf16 v119, v143, v163
  v_perm_b32 v147, v117, v113, s52
  v_perm_b32 v151, v117, v113, s53
  v_dot2c_f32_bf16 v123, v147, v163
  v_dot2c_f32_bf16 v127, v151, v163
  v_perm_b32 v139, v118, v114, s52
  v_perm_b32 v143, v118, v114, s53
  v_dot2c_f32_bf16 v131, v139, v163
  v_dot2c_f32_bf16 v135, v143, v163
  ds_read_b128 v[160:163], v67 offset:192
  buffer_load_dwordx3 v[112:114], v1, s[36:39], s46 offen nt
  s_addk_i32 s46, 6144
  buffer_load_dwordx3 v[116:118], v1, s[36:39], s46 offen nt
  s_addk_i32 s46, 6144
  s_waitcnt lgkmcnt(1)
  s_waitcnt vmcnt(30)
  v_perm_b32 v139, v124, v120, s52
  v_perm_b32 v143, v124, v120, s53
  v_dot2c_f32_bf16 v115, v139, v164
  v_dot2c_f32_bf16 v119, v143, v164
  v_perm_b32 v147, v125, v121, s52
  v_perm_b32 v151, v125, v121, s53
  v_dot2c_f32_bf16 v123, v147, v164
  v_dot2c_f32_bf16 v127, v151, v164
  v_perm_b32 v139, v126, v122, s52
  v_perm_b32 v143, v126, v122, s53
  v_dot2c_f32_bf16 v131, v139, v164
  v_dot2c_f32_bf16 v135, v143, v164
  buffer_load_dwordx3 v[120:122], v1, s[36:39], s46 offen nt
  s_addk_i32 s46, 6144
  buffer_load_dwordx3 v[124:126], v1, s[36:39], s46 offen nt
  s_addk_i32 s46, 6144
  s_waitcnt vmcnt(30)
  v_perm_b32 v139, v132, v128, s52
  v_perm_b32 v143, v132, v128, s53
  v_dot2c_f32_bf16 v115, v139, v165
  v_dot2c_f32_bf16 v119, v143, v165
  v_perm_b32 v147, v133, v129, s52
  v_perm_b32 v151, v133, v129, s53
  v_dot2c_f32_bf16 v123, v147, v165
  v_dot2c_f32_bf16 v127, v151, v165
  v_perm_b32 v139, v134, v130, s52
  v_perm_b32 v143, v134, v130, s53
  v_dot2c_f32_bf16 v131, v139, v165
  v_dot2c_f32_bf16 v135, v143, v165
  buffer_load_dwordx3 v[128:130], v1, s[36:39], s46 offen nt
  s_addk_i32 s46, 6144
  buffer_load_dwordx3 v[132:134], v1, s[36:39], s46 offen nt
  s_addk_i32 s46, 6144
  s_waitcnt vmcnt(30)
  v_perm_b32 v139, v12, v8, s52
  v_perm_b32 v143, v12, v8, s53
  v_dot2c_f32_bf16 v115, v139, v166
  v_dot2c_f32_bf16 v119, v143, v166
  v_perm_b32 v147, v13, v9, s52
  v_perm_b32 v151, v13, v9, s53
  v_dot2c_f32_bf16 v123, v147, v166
  v_dot2c_f32_bf16 v127, v151, v166
  v_perm_b32 v139, v14, v10, s52
  v_perm_b32 v143, v14, v10, s53
  v_dot2c_f32_bf16 v131, v139, v166
  v_dot2c_f32_bf16 v135, v143, v166
  s_cmp_eq_u32 s44, 7
  s_cbranch_scc0 L_tk_3
  v_mov_b32 v6, 17548
  v_mov_b32 v7, 1
  ds_write_b32 v6, v7
L_tk_3:
  buffer_load_dwordx3 v[8:10], v1, s[36:39], s46 offen nt
  s_addk_i32 s46, 6144
  buffer_load_dwordx3 v[12:14], v1, s[36:39], s46 offen nt
  s_addk_i32 s46, 6144
  s_waitcnt vmcnt(30)
  v_perm_b32 v139, v20, v16, s52
  v_perm_b32 v143, v20, v16, s53
  v_dot2c_f32_bf16 v115, v139, v167
  v_dot2c_f32_bf16 v119, v143, v167
  v_perm_b32 v147, v21, v17, s52
  v_perm_b32 v151, v21, v17, s53
  v_dot2c_f32_bf16 v123, v147, v167
  v_dot2c_f32_bf16 v127, v151, v167
  v_perm_b32 v139, v22, v18, s52
  v_perm_b32 v143, v22, v18, s53
  v_dot2c_f32_bf16 v131, v139, v167
  v_dot2c_f32_bf16 v135, v143, v167
  ds_read_b128 v[164:167], v67 offset:208
  buffer_load_dwordx3 v[16:18], v1, s[36:39], s46 offen nt
  s_addk_i32 s46, 6144
  buffer_load_dwordx3 v[20:22], v1, s[36:39], s46 offen nt
  s_addk_i32 s46, 6144
  s_waitcnt lgkmcnt(1)
  s_waitcnt vmcnt(30)
  v_perm_b32 v139, v28, v24, s52
  v_perm_b32 v143, v28, v24, s53
  v_dot2c_f32_bf16 v115, v139, v160
  v_dot2c_f32_bf16 v119, v143, v160
  v_perm_b32 v147, v29, v25, s52
  v_perm_b32 v151, v29, v25, s53
  v_dot2c_f32_bf16 v123, v147, v160
  v_dot2c_f32_bf16 v127, v151, v160
  v_perm_b32 v139, v30, v26, s52
  v_perm_b32 v143, v30, v26, s53
  v_dot2c_f32_bf16 v131, v139, v160
  v_dot2c_f32_bf16 v135, v143, v160
  buffer_load_dwordx3 v[24:26], v1, s[36:39], s46 offen nt
  s_addk_i32 s46, 6144
  buffer_load_dwordx3 v[28:30], v1, s[36:39], s46 offen nt
  s_addk_i32 s46, 6144
  s_waitcnt vmcnt(30)
  v_perm_b32 v139, v36, v32, s52
  v_perm_b32 v143, v36, v32, s53
  v_dot2c_f32_bf16 v115, v139, v161
  v_dot2c_f32_bf16 v119, v143, v161
  v_perm_b32 v147, v37, v33, s52
  v_perm_b32 v151, v37, v33, s53
  v_dot2c_f32_bf16 v123, v147, v161
  v_dot2c_f32_bf16 v127, v151, v161
  v_perm_b32 v139, v38, v34, s52
  v_perm_b32 v143, v38, v34, s53
  v_dot2c_f32_bf16 v131, v139, v161
  v_dot2c_f32_bf16 v135, v143, v161
  buffer_load_dwordx3 v[32:34], v1, s[36:39], s46 offen nt
  s_addk_i32 s46, 6144
  buffer_load_dwordx3 v[36:38], v1, s[36:39], s46 offen nt
  s_waitcnt vmcnt(30)
  v_perm_b32 v139, v44, v40, s52
  v_perm_b32 v143, v44, v40, s53
  v_dot2c_f32_bf16 v115, v139, v162
  v_dot2c_f32_bf16 v119, v143, v162
  v_perm_b32 v147, v45, v41, s52
  v_perm_b32 v151, v45, v41, s53
  v_dot2c_f32_bf16 v123, v147, v162
  v_dot2c_f32_bf16 v127, v151, v162
  v_perm_b32 v139, v46, v42, s52
  v_perm_b32 v143, v46, v42, s53
  v_dot2c_f32_bf16 v131, v139, v162
  v_dot2c_f32_bf16 v135, v143, v162
  s_waitcnt vmcnt(28)
  v_perm_b32 v139, v52, v48, s52
  v_perm_b32 v143, v52, v48, s53
  v_dot2c_f32_bf16 v115, v139, v163
  v_dot2c_f32_bf16 v119, v143, v163
  v_perm_b32 v147, v53, v49, s52
  v_perm_b32 v151, v53, v49, s53
  v_dot2c_f32_bf16 v123, v147, v163
  v_dot2c_f32_bf16 v127, v151, v163
  v_perm_b32 v139, v54, v50, s52
  v_perm_b32 v143, v54, v50, s53
  v_dot2c_f32_bf16 v131, v139, v163
  v_dot2c_f32_bf16 v135, v143, v163
  ds_read_b128 v[160:163], v67 offset:224
  s_waitcnt lgkmcnt(1)
  s_waitcnt vmcnt(26)
  v_perm_b32 v139, v60, v56, s52
  v_perm_b32 v143, v60, v56, s53
  v_dot2c_f32_bf16 v115, v139, v164
  v_dot2c_f32_bf16 v119, v143, v164
  v_perm_b32 v147, v61, v57, s52
  v_perm_b32 v151, v61, v57, s53
  v_dot2c_f32_bf16 v123, v147, v164
  v_dot2c_f32_bf16 v127, v151, v164
  v_perm_b32 v139, v62, v58, s52
  v_perm_b32 v143, v62, v58, s53
  v_dot2c_f32_bf16 v131, v139, v164
  v_dot2c_f32_bf16 v135, v143, v164
  s_waitcnt vmcnt(24)
  v_perm_b32 v139, v68, v64, s52
  v_perm_b32 v143, v68, v64, s53
  v_dot2c_f32_bf16 v115, v139, v165
  v_dot2c_f32_bf16 v119, v143, v165
  v_perm_b32 v147, v69, v65, s52
  v_perm_b32 v151, v69, v65, s53
  v_dot2c_f32_bf16 v123, v147, v165
  v_dot2c_f32_bf16 v127, v151, v165
  v_perm_b32 v139, v70, v66, s52
  v_perm_b32 v143, v70, v66, s53
  v_dot2c_f32_bf16 v131, v139, v165
  v_dot2c_f32_bf16 v135, v143, v165
  s_waitcnt vmcnt(22)
  v_perm_b32 v139, v76, v72, s52
  v_perm_b32 v143, v76, v72, s53
  v_dot2c_f32_bf16 v115, v139, v166
  v_dot2c_f32_bf16 v119, v143, v166
  v_perm_b32 v147, v77, v73, s52
  v_perm_b32 v151, v77, v73, s53
  v_dot2c_f32_bf16 v123, v147, v166
  v_dot2c_f32_bf16 v127, v151, v166
  v_perm_b32 v139, v78, v74, s52
  v_perm_b32 v143, v78, v74, s53
  v_dot2c_f32_bf16 v131, v139, v166
  v_dot2c_f32_bf16 v135, v143, v166
  s_waitcnt vmcnt(20)
  v_perm_b32 v139, v84, v80, s52
  v_perm_b32 v143, v84, v80, s53
  v_dot2c_f32_bf16 v115, v139, v167
  v_dot2c_f32_bf16 v119, v143, v167
  v_perm_b32 v147, v85, v81, s52
  v_perm_b32 v151, v85, v81, s53
  v_dot2c_f32_bf16 v123, v147, v167
  v_dot2c_f32_bf16 v127, v151, v167
  v_perm_b32 v139, v86, v82, s52
  v_perm_b32 v143, v86, v82, s53
  v_dot2c_f32_bf16 v131, v139, v167
  v_dot2c_f32_bf16 v135, v143, v167
  ds_read_b128 v[164:167], v67 offset:240
  s_waitcnt lgkmcnt(1)
  s_waitcnt vmcnt(18)
  v_perm_b32 v139, v92, v88, s52
  v_perm_b32 v143, v92, v88, s53
  v_dot2c_f32_bf16 v115, v139, v160
  v_dot2c_f32_bf16 v119, v143, v160
  v_perm_b32 v147, v93, v89, s52
  v_perm_b32 v151, v93, v89, s53
  v_dot2c_f32_bf16 v123, v147, v160
  v_dot2c_f32_bf16 v127, v151, v160
  v_perm_b32 v139, v94, v90, s52
  v_perm_b32 v143, v94, v90, s53
  v_dot2c_f32_bf16 v131, v139, v160
  v_dot2c_f32_bf16 v135, v143, v160
  s_waitcnt vmcnt(16)
  v_perm_b32 v139, v100, v96, s52
  v_perm_b32 v143, v100, v96, s53
  v_dot2c_f32_bf16 v115, v139, v161
  v_dot2c_f32_bf16 v119, v143, v161
  v_perm_b32 v147, v101, v97, s52
  v_perm_b32 v151, v101, v97, s53
  v_dot2c_f32_bf16 v123, v147, v161
  v_dot2c_f32_bf16 v127, v151, v161
  v_perm_b32 v139, v102, v98, s52
  v_perm_b32 v143, v102, v98, s53
  v_dot2c_f32_bf16 v131, v139, v161
  v_dot2c_f32_bf16 v135, v143, v161
  s_waitcnt vmcnt(14)
  v_perm_b32 v139, v108, v104, s52
  v_perm_b32 v143, v108, v104, s53
  v_dot2c_f32_bf16 v115, v139, v162
  v_dot2c_f32_bf16 v119, v143, v162
  v_perm_b32 v147, v109, v105, s52
  v_perm_b32 v151, v109, v105, s53
  v_dot2c_f32_bf16 v123, v147, v162
  v_dot2c_f32_bf16 v127, v151, v162
  v_perm_b32 v139, v110, v106, s52
  v_perm_b32 v143, v110, v106, s53
  v_dot2c_f32_bf16 v131, v139, v162
  v_dot2c_f32_bf16 v135, v143, v162
  s_waitcnt vmcnt(12)
  v_perm_b32 v139, v116, v112, s52
  v_perm_b32 v143, v116, v112, s53
  v_dot2c_f32_bf16 v115, v139, v163
  v_dot2c_f32_bf16 v119, v143, v163
  v_perm_b32 v147, v117, v113, s52
  v_perm_b32 v151, v117, v113, s53
  v_dot2c_f32_bf16 v123, v147, v163
  v_dot2c_f32_bf16 v127, v151, v163
  v_perm_b32 v139, v118, v114, s52
  v_perm_b32 v143, v118, v114, s53
  v_dot2c_f32_bf16 v131, v139, v163
  v_dot2c_f32_bf16 v135, v143, v163
  ds_read_b128 v[160:163], v67 offset:256
  s_waitcnt lgkmcnt(1)
  s_waitcnt vmcnt(10)
  v_perm_b32 v139, v124, v120, s52
  v_perm_b32 v143, v124, v120, s53
  v_dot2c_f32_bf16 v115, v139, v164
  v_dot2c_f32_bf16 v119, v143, v164
  v_perm_b32 v147, v125, v121, s52
  v_perm_b32 v151, v125, v121, s53
  v_dot2c_f32_bf16 v123, v147, v164
  v_dot2c_f32_bf16 v127, v151, v164
  v_perm_b32 v139, v126, v122, s52
  v_perm_b32 v143, v126, v122, s53
  v_dot2c_f32_bf16 v131, v139, v164
  v_dot2c_f32_bf16 v135, v143, v164
  s_waitcnt vmcnt(8)
  v_perm_b32 v139, v132, v128, s52
  v_perm_b32 v143, v132, v128, s53
  v_dot2c_f32_bf16 v115, v139, v165
  v_dot2c_f32_bf16 v119, v143, v165
  v_perm_b32 v147, v133, v129, s52
  v_perm_b32 v151, v133, v129, s53
  v_dot2c_f32_bf16 v123, v147, v165
  v_dot2c_f32_bf16 v127, v151, v165
  v_perm_b32 v139, v134, v130, s52
  v_perm_b32 v143, v134, v130, s53
  v_dot2c_f32_bf16 v131, v139, v165
  v_dot2c_f32_bf16 v135, v143, v165
  s_waitcnt vmcnt(6)
  v_perm_b32 v139, v12, v8, s52
  v_perm_b32 v143, v12, v8, s53
  v_dot2c_f32_bf16 v115, v139, v166
  v_dot2c_f32_bf16 v119, v143, v166
  v_perm_b32 v147, v13, v9, s52
  v_perm_b32 v151, v13, v9, s53
  v_dot2c_f32_bf16 v123, v147, v166
  v_dot2c_f32_bf16 v127, v151, v166
  v_perm_b32 v139, v14, v10, s52
  v_perm_b32 v143, v14, v10, s53
  v_dot2c_f32_bf16 v131, v139, v166
  v_dot2c_f32_bf16 v135, v143, v166
  s_waitcnt vmcnt(4)
  v_perm_b32 v139, v20, v16, s52
  v_perm_b32 v143, v20, v16, s53
  v_dot2c_f32_bf16 v115, v139, v167
  v_dot2c_f32_bf16 v119, v143, v167
  v_perm_b32 v147, v21, v17, s52
  v_perm_b32 v151, v21, v17, s53
  v_dot2c_f32_bf16 v123, v147, v167
  v_dot2c_f32_bf16 v127, v151, v167
  v_perm_b32 v139, v22, v18, s52
  v_perm_b32 v143, v22, v18, s53
  v_dot2c_f32_bf16 v131, v139, v167
  v_dot2c_f32_bf16 v135, v143, v167
  s_waitcnt lgkmcnt(0)
  s_waitcnt vmcnt(2)
  v_perm_b32 v139, v28, v24, s52
  v_perm_b32 v143, v28, v24, s53
  v_dot2c_f32_bf16 v115, v139, v160
  v_dot2c_f32_bf16 v119, v143, v160
  v_perm_b32 v147, v29, v25, s52
  v_perm_b32 v151, v29, v25, s53
  v_dot2c_f32_bf16 v123, v147, v160
  v_dot2c_f32_bf16 v127, v151, v160
  v_perm_b32 v139, v30, v26, s52
  v_perm_b32 v143, v30, v26, s53
  v_dot2c_f32_bf16 v131, v139, v160
  v_dot2c_f32_bf16 v135, v143, v160
  s_waitcnt vmcnt(0)
  v_perm_b32 v139, v36, v32, s52
  v_perm_b32 v143, v36, v32, s53
  v_dot2c_f32_bf16 v115, v139, v161
  v_dot2c_f32_bf16 v119, v143, v161
  v_perm_b32 v147, v37, v33, s52
  v_perm_b32 v151, v37, v33, s53
  v_dot2c_f32_bf16 v123, v147, v161
  v_dot2c_f32_bf16 v127, v151, v161
  v_perm_b32 v139, v38, v34, s52
  v_perm_b32 v143, v38, v34, s53
  v_dot2c_f32_bf16 v131, v139, v161
  v_dot2c_f32_bf16 v135, v143, v161
  v_permlane32_swap_b32 v115, v127
  v_add_f32 v115, v115, v127
  v_permlane32_swap_b32 v119, v131
  v_add_f32 v119, v119, v131
  v_permlane32_swap_b32 v123, v135
  v_add_f32 v123, v123, v135
  v_and_b32 v6, 31, v5
  v_mul_u32_u24 v6, 24, v6
  v_lshrrev_b32 v7, 5, v5
  v_mad_u32_u24 v6, v7, 12, v6
  s_mul_i32 s45, s44, 768
  s_add_u32 s45, s45, 23040
  v_add_u32 v6, s45, v6
  ds_write_b32 v6, v115 offset:0
  ds_write_b32 v6, v119 offset:4
  ds_write_b32 v6, v123 offset:8
  s_waitcnt lgkmcnt(0)
  s_barrier
  s_add_u32 s44, s44, 4
  s_branch L_post
L_post:
L_hopA_0:
  s_cbranch_execz L_hopA_1
  s_nop 3
  s_setprio 0
  v_and_b32 v5, 63, v0
  s_cmp_lg_u32 s44, 0
  s_cbranch_scc1 L_o_done
  v_lshlrev_b32 v6, 4, v5
  s_mov_b32 exec_lo, -1
  s_mov_b32 exec_hi, 0xffff
  ds_read_b128 v[8:11], v6 offset:23040
  ds_read_b128 v[12:15], v6 offset:23808
  ds_read_b128 v[16:19], v6 offset:24576
  ds_read_b128 v[20:23], v6 offset:25344
  ds_read_b128 v[24:27], v6 offset:26112
  ds_read_b128 v[28:31], v6 offset:26880
L_hopA_1:
  s_cbranch_execz L_hopA_2
  ds_read_b128 v[32:35], v6 offset:27648
  ds_read_b128 v[36:39], v6 offset:28416
  s_waitcnt lgkmcnt(6)
  v_add_f32 v8, v8, v12
  v_add_f32 v9, v9, v13
  v_add_f32 v10, v10, v14
  v_add_f32 v11, v11, v15
  s_waitcnt lgkmcnt(5)
  v_add_f32 v8, v8, v16
  v_add_f32 v9, v9, v17
  v_add_f32 v10, v10, v18
  v_add_f32 v11, v11, v19
  s_waitcnt lgkmcnt(4)
  v_add_f32 v8, v8, v20
L_hopA_2:
  s_cbranch_execz L_hopA_3
  v_add_f32 v9, v9, v21
  v_add_f32 v10, v10, v22
  v_add_f32 v11, v11, v23
  s_waitcnt lgkmcnt(3)
  v_add_f32 v8, v8, v24
  v_add_f32 v9, v9, v25
  v_add_f32 v10, v10, v26
  v_add_f32 v11, v11, v27
  s_waitcnt lgkmcnt(2)
  v_add_f32 v8, v8, v28
  v_add_f32 v9, v9, v29
  v_add_f32 v10, v10, v30
  v_add_f32 v11, v11, v31
  s_waitcnt lgkmcnt(1)
L_hopA_3:
  s_cbranch_execz L_hopA_4
  v_add_f32 v8, v8, v32
  v_add_f32 v9, v9, v33
  v_add_f32 v10, v10, v34
  v_add_f32 v11, v11, v35
  s_waitcnt lgkmcnt(0)
  v_add_f32 v8, v8, v36
  v_add_f32 v9, v9, v37
  v_add_f32 v10, v10, v38
  v_add_f32 v11, v11, v39
  v_min_u32 v8, -2, v8
  v_min_u32 v9, -2, v9
  v_min_u32 v10, -2, v10
  v_min_u32 v11, -2, v11
  s_lshl_b32 s45, s57, 5
L_hopA_4:
  s_cbranch_execz L_hopA_5
  s_add_u32 s45, s45, s58
  s_lshl_b32 s45, s45, 1
  s_add_u32 s45, s45, s59
  s_mul_i32 s45, s45, 768
  s_add_u32 s45, s45, 262144
  buffer_store_dwordx4 v[8:11], v6, s[40:43], s45 offen sc1
  s_mov_b64 exec, -1
L_o_done:
  s_nop 1
  v_mov_b32 v6, 17544
  ds_read_b32 v7, v6
  s_waitcnt lgkmcnt(0)
  v_readfirstlane_b32 s45, v7
  s_cmp_lt_u32 s45, 40
  s_cselect_b32 s92, s45, -1
L_hopA_5:
  s_cbranch_execz L_hopA_6
  s_mov_b32 s83, s45
  s_cmp_lt_u32 s45, 48
  s_cselect_b32 s82, 2, 0
  s_cbranch_scc1 L_ticket_done
  s_sub_u32 s45, s45, 48
  s_cmp_lt_u32 s45, 80
  s_cselect_b32 s82, 1, 0
  s_mul_i32 s46, s45, 6554
  s_lshr_b32 s46, s46, 16
  s_mov_b32 s84, s46
  s_mul_i32 s47, s46, 10
  s_sub_u32 s83, s45, s47
L_ticket_done:
  s_cmp_eq_u32 s82, 0
  s_cbranch_scc1 L_tail
L_hopA_6:
  s_cbranch_execz L_hopA_7
  s_barrier
  s_cmp_eq_u32 s82, 1
  s_cbranch_scc0 L_post23
  s_mul_i32 s45, s84, 983040
  s_lshl_b32 s46, s83, 7
  s_add_u32 s47, s45, s46
  s_add_u32 s32, s12, s47
  s_addc_u32 s33, s13, 0
  s_mov_b32 s34, 983040
  s_mov_b32 s35, 0x20000
  v_lshrrev_b32 v6, 3, v5
  v_bfe_u32 v7, v5, 4, 1
  v_lshlrev_b32 v7, 5, v7
  v_and_b32 v8, 7, v5
L_hopA_7:
  s_cbranch_execz L_hopA_8
  v_lshlrev_b32 v8, 4, v8
  v_xor_b32 v8, v8, v7
  v_xor_b32 v9, 64, v8
  s_mov_b32 s45, 1280
  v_mul_lo_u32 v6, s45, v6
  v_add_u32 v8, v8, v6
  v_add_u32 v9, v9, v6
  s_mul_i32 s46, s44, 81920
  s_lshl_b32 s47, s44, 13
  s_add_u32 s47, s47, 29184
  s_mov_b32 s63, 4
L_wo_dma:
  s_mov_b32 m0, s47
  s_add_u32 s47, s47, 1024
  buffer_load_dwordx4 v8, s[32:35], s46 offen nt lds
L_hopA_8:
  s_cbranch_execz L_hopA_9
  s_add_u32 s46, s46, 10240
  s_mov_b32 m0, s47
  s_add_u32 s47, s47, 1024
  buffer_load_dwordx4 v9, s[32:35], s46 offen nt lds
  s_add_u32 s46, s46, 10240
  s_sub_u32 s63, s63, 1
  s_cmp_lg_u32 s63, 0
  s_cbranch_scc1 L_wo_dma
  s_mul_i32 s45, s44, 21846
  s_lshr_b32 s45, s45, 16
  s_mul_i32 s46, s45, 3
  s_sub_u32 s46, s44, s46
  s_lshl_b32 s46, s46, 6
  v_add_u32 v10, s46, v5
L_hopA_9:
  s_cbranch_execz L_hopA_10
  v_mul_u32_u24 v11, 1366, v10
  v_lshrrev_b32 v11, 16, v11
  v_mul_u32_u24 v12, 48, v11
  v_sub_u32 v12, v10, v12
  v_mul_u32_u24 v11, 1536, v11
  v_lshl_add_u32 v11, v12, 4, v11
  s_lshl_b32 s63, s45, 5
  s_lshl_b32 s46, s84, 2
  s_add_u32 s63, s63, s46
  s_mul_i32 s63, s63, 1536
  s_add_u32 s63, s63, 262144
  s_mul_i32 s46, s45, 1600
  s_add_u32 s46, s46, 0
  v_lshl_add_u32 v13, v10, 3, s46
L_hopA_10:
  s_cbranch_execz L_hopA_11
  v_lshrrev_b32 v6, 4, v5
  v_bfe_u32 v7, v5, 2, 2
  v_lshl_add_u32 v14, v6, 3, v7
  v_lshlrev_b32 v14, 7, v14
  v_and_b32 v6, 1, v6
  v_lshlrev_b32 v6, 6, v6
  v_bfe_u32 v7, v5, 3, 1
  v_lshlrev_b32 v7, 5, v7
  v_or3_b32 v14, v14, v6, v7
  v_and_b32 v6, 3, v5
  v_lshl_add_u32 v14, v6, 3, v14
  s_and_b32 s45, s44, 3
  s_lshl_b32 s45, s45, 5
  v_xor_b32 v14, s45, v14
L_hopA_11:
  s_cbranch_execz L_hopA_12
  s_lshr_b32 s45, s44, 2
  s_lshl_b32 s46, s45, 15
  s_add_u32 s46, s46, 29184
  v_add_u32 v14, s46, v14
  v_and_b32 v6, 3, v5
  v_mul_u32_u24 v15, 1600, v6
  v_lshrrev_b32 v6, 4, v5
  v_lshl_add_u32 v15, v6, 4, v15
  s_lshl_b32 s46, s45, 9
  s_add_u32 s46, s46, 0
  v_add_u32 v15, s46, v15
  v_lshrrev_b32 v16, 4, v5
  v_and_b32 v6, 3, v5
  v_lshl_add_u32 v16, v16, 2, v6
L_hopA_12:
  s_cbranch_execz L_hopA_13
  v_lshlrev_b32 v16, 4, v16
  v_and_b32 v17, 3, v5
  v_mul_u32_u24 v17, 2560, v17
  v_lshrrev_b32 v7, 2, v5
  v_lshl_add_u32 v17, v7, 4, v17
  s_waitcnt vmcnt(0)
  s_barrier
  ds_read_b64_tr_b16 v[40:41], v14 offset:0
  ds_read_b64_tr_b16 v[42:43], v14 offset:512
  ds_read_b64_tr_b16 v[44:45], v14 offset:4096
  ds_read_b64_tr_b16 v[46:47], v14 offset:4608
  ds_read_b64_tr_b16 v[48:49], v14 offset:8192
  ds_read_b64_tr_b16 v[50:51], v14 offset:8704
  ds_read_b64_tr_b16 v[52:53], v14 offset:12288
L_hopA_13:
  s_cbranch_execz L_hopA_14
  ds_read_b64_tr_b16 v[54:55], v14 offset:12800
  ds_read_b64_tr_b16 v[56:57], v14 offset:16384
  ds_read_b64_tr_b16 v[58:59], v14 offset:16896
  ds_read_b64_tr_b16 v[60:61], v14 offset:20480
  ds_read_b64_tr_b16 v[62:63], v14 offset:20992
  ds_read_b64_tr_b16 v[64:65], v14 offset:24576
  ds_read_b64_tr_b16 v[66:67], v14 offset:25088
  ds_read_b64_tr_b16 v[68:69], v14 offset:28672
  ds_read_b64_tr_b16 v[70:71], v14 offset:29184
  s_mov_b32 s62, 0
L_po:
  buffer_load_dwordx4 v[20:23], v11, s[40:43], s63 offen sc1
  buffer_load_dwordx4 v[24:27], v11, s[40:43], s63 offen offset:768 sc1
  s_add_u32 s62, s62, 1
  s_waitcnt vmcnt(0)
L_hopA_14:
  s_cbranch_execz L_hopA_15
  v_max3_u32 v6, v20, v21, v22
  v_max3_u32 v6, v6, v23, v24
  v_max3_u32 v6, v6, v25, v26
  v_max_u32 v6, v6, v27
  v_cmp_eq_u32 vcc, -1, v6
  s_cmp_eq_u64 vcc, 0
  s_cbranch_scc1 L_po_ok
  s_cmp_lt_u32 s62, 65536
  s_cbranch_scc1 L_po
L_po_ok:
  v_add_f32 v20, v20, v24
  v_add_f32 v21, v21, v25
  v_add_f32 v22, v22, v26
  v_add_f32 v23, v23, v27
  v_cvt_pk_bf16_f32 v20, v20, v21
L_hopA_15:
  s_cbranch_execz L_hopA_16
  v_cvt_pk_bf16_f32 v21, v22, v23
  ds_write_b64 v13, v[20:21]
  s_waitcnt lgkmcnt(0)
  s_barrier
  ds_read_b128 v[72:75], v15 offset:0
  ds_read_b128 v[76:79], v15 offset:64
  ds_read_b128 v[80:83], v15 offset:128
  ds_read_b128 v[84:87], v15 offset:192
  ds_read_b128 v[88:91], v15 offset:256
  ds_read_b128 v[92:95], v15 offset:320
  ds_read_b128 v[96:99], v15 offset:384
  ds_read_b128 v[100:103], v15 offset:448
  s_waitcnt lgkmcnt(7)
  v_mfma_f32_16x16x32_bf16 v[20:23], v[40:43], v[72:75], 0
L_hopA_16:
  s_cbranch_execz L_hopA_17
  s_waitcnt lgkmcnt(6)
  v_mfma_f32_16x16x32_bf16 v[20:23], v[44:47], v[76:79], v[20:23]
  s_waitcnt lgkmcnt(5)
  v_mfma_f32_16x16x32_bf16 v[20:23], v[48:51], v[80:83], v[20:23]
  s_waitcnt lgkmcnt(4)
  v_mfma_f32_16x16x32_bf16 v[20:23], v[52:55], v[84:87], v[20:23]
  s_waitcnt lgkmcnt(3)
  v_mfma_f32_16x16x32_bf16 v[20:23], v[56:59], v[88:91], v[20:23]
  s_waitcnt lgkmcnt(2)
  v_mfma_f32_16x16x32_bf16 v[20:23], v[60:63], v[92:95], v[20:23]
  s_waitcnt lgkmcnt(1)
  v_mfma_f32_16x16x32_bf16 v[20:23], v[64:67], v[96:99], v[20:23]
  s_waitcnt lgkmcnt(0)
  v_mfma_f32_16x16x32_bf16 v[20:23], v[68:71], v[100:103], v[20:23]
L_hopA_17:
  s_cbranch_execz L_hopA_18
  s_lshl_b32 s45, s44, 8
  s_add_u32 s45, s45, 12800
  v_add_u32 v16, s45, v16
  s_mov_b32 exec_lo, 0xf000f
  s_mov_b32 exec_hi, 0xf000f
  s_nop 1
  ds_write_b128 v16, v[20:23]
  s_mov_b64 exec, -1
  s_waitcnt lgkmcnt(0)
  s_barrier
  s_cmp_lg_u32 s44, 0
  s_cbranch_scc1 L_wo_done
  v_lshlrev_b32 v6, 4, v5
  ds_read_b128 v[20:23], v6 offset:12800
  ds_read_b128 v[24:27], v6 offset:13824
L_hopA_18:
  s_cbranch_execz L_hopA_19
  ds_read_b128 v[28:31], v6 offset:14848
  s_mul_i32 s45, s84, 10240
  s_lshl_b32 s46, s83, 8
  s_add_u32 s45, s45, s46
  s_add_u32 s45, s45, 458752
  s_waitcnt lgkmcnt(0)
  v_add_f32 v20, v20, v24
  v_add_f32 v21, v21, v25
  v_add_f32 v22, v22, v26
  v_add_f32 v23, v23, v27
  v_add_f32 v20, v20, v28
  v_add_f32 v21, v21, v29
  v_add_f32 v22, v22, v30
  v_add_f32 v23, v23, v31
L_hopA_19:
  s_cbranch_execz L_hopA_20
  v_min_u32 v20, -2, v20
  v_min_u32 v21, -2, v21
  v_min_u32 v22, -2, v22
  v_min_u32 v23, -2, v23
  buffer_store_dwordx4 v[20:23], v17, s[40:43], s45 offen sc1
L_wo_done:
  s_branch L_tail
L_hopA_20:
  s_cbranch_execz L_warm_ret
L_post23:
L_hopB_0:
  s_cbranch_execz L_hopB_1
  s_nop 1
  s_mul_i32 s45, s44, 21846
  s_lshr_b32 s87, s45, 16
  s_mul_i32 s46, s87, 3
  s_sub_u32 s88, s44, s46
  s_mul_i32 s46, s88, 54
  v_add_u32 v10, s46, v5
  v_cmp_gt_u32 vcc, 54, v5
  s_mov_b64 s[50:51], vcc
  v_mov_b32 v6, 160
  v_cmp_lt_u32 vcc, v10, v6
  s_and_b64 s[50:51], s[50:51], vcc
  v_min_u32 v10, 159, v10
  v_lshlrev_b32 v11, 3, v10
L_hopB_1:
  s_cbranch_execz L_hopB_2
  s_mul_i32 s46, s87, 7680
  s_add_u32 s46, s46, 0
  s_mov_b32 s36, s4
  s_mov_b32 s37, s5
  s_mov_b32 s38, 5120
  s_mov_b32 s39, 0x20000
  s_mul_i32 s47, s87, 1280
  buffer_load_dwordx2 v[18:19], v11, s[36:39], s47 offen
  v_add_u32 v40, 2560, v11
  v_add_u32 v41, 3840, v11
  v_add_u32 v42, 5120, v11
  s_mul_i32 s85, s87, 7680
  s_add_u32 s85, s85, 0
  v_lshlrev_b32 v32, 4, v10
L_hopB_2:
  s_cbranch_execz L_hopB_3
  s_mul_i32 s86, s87, 2560
  s_add_u32 s86, s86, 458752
  v_add_u32 v140, 0, v32
  v_add_u32 v141, 10240, v32
  v_add_u32 v142, 20480, v32
  v_add_u32 v143, 30720, v32
  v_add_u32 v144, 40960, v32
  v_add_u32 v145, 51200, v32
  v_add_u32 v146, 61440, v32
  v_add_u32 v147, 71680, v32
  buffer_load_dwordx2 v[12:13], v40, s[40:43], s85 offen sc1
  buffer_load_dwordx2 v[14:15], v41, s[40:43], s85 offen sc1
  buffer_load_dwordx2 v[16:17], v42, s[40:43], s85 offen sc1
  s_cmp_ge_u32 s44, 10
L_hopB_3:
  s_cbranch_execz L_hopB_4
  s_cbranch_scc1 L_gu_dn
  s_lshl_b32 s47, s83, 6
  s_cmp_ge_u32 s44, 5
  s_cselect_b32 s48, s18, s16
  s_cselect_b32 s49, s19, s17
  s_cselect_b32 s63, 5, 0
  s_add_u32 s32, s48, s47
  s_addc_u32 s33, s49, 0
  s_mov_b32 s34, 1966080
  s_mov_b32 s35, 0x20000
  v_lshrrev_b32 v6, 2, v5
  v_bfe_u32 v7, v5, 5, 1
  v_lshlrev_b32 v7, 5, v7
  v_and_b32 v8, 3, v5
L_hopB_4:
  s_cbranch_execz L_hopB_5
  v_lshlrev_b32 v8, 4, v8
  v_xor_b32 v8, v8, v7
  v_mul_u32_u24 v6, 3072, v6
  v_add_u32 v8, v8, v6
  s_sub_u32 s63, s44, s63
  s_mul_i32 s46, s63, 393216
  s_lshl_b32 s47, s44, 13
  s_add_u32 s47, s47, 29184
  s_mov_b32 s63, 4
L_gu_dma:
  s_mov_b32 m0, s47
  s_add_u32 s47, s47, 1024
  buffer_load_dwordx4 v8, s[32:35], s46 offen  lds
  s_add_u32 s46, s46, 49152
  s_mov_b32 m0, s47
L_hopB_5:
  s_cbranch_execz L_hopB_6
  s_add_u32 s47, s47, 1024
  buffer_load_dwordx4 v8, s[32:35], s46 offen  lds
  s_add_u32 s46, s46, 49152
  s_sub_u32 s63, s63, 1
  s_cmp_lg_u32 s63, 0
  s_cbranch_scc1 L_gu_dma
  s_waitcnt vmcnt(8)
  s_branch L_gu_dma_done
L_gu_dn:
  s_mul_i32 s45, s83, 40960
  s_add_u32 s32, s20, s45
  s_addc_u32 s33, s21, 0
  s_mov_b32 s34, 40960
  s_mov_b32 s35, 0x20000
  v_lshlrev_b32 v6, 4, v5
L_hopB_6:
  s_cbranch_execz L_hopB_7
  v_add_u32 v6, 0, v6
  v_mul_u32_u24 v7, 3277, v6
  v_lshrrev_b32 v7, 22, v7
  v_mul_u32_u24 v8, 1280, v7
  v_sub_u32 v6, v6, v8
  v_lshlrev_b32 v7, 5, v7
  v_xor_b32 v9, v6, v7
  v_add_u32 v148, v8, v9
  v_xor_b32 v9, 128, v9
  v_add_u32 v153, v8, v9
  v_lshlrev_b32 v6, 4, v5
  v_add_u32 v6, 1024, v6
  v_mul_u32_u24 v7, 3277, v6
  v_lshrrev_b32 v7, 22, v7
L_hopB_7:
  s_cbranch_execz L_hopB_8
  v_mul_u32_u24 v8, 1280, v7
  v_sub_u32 v6, v6, v8
  v_lshlrev_b32 v7, 5, v7
  v_xor_b32 v9, v6, v7
  v_add_u32 v149, v8, v9
  v_xor_b32 v9, 128, v9
  v_add_u32 v154, v8, v9
  v_lshlrev_b32 v6, 4, v5
  v_add_u32 v6, 2048, v6
  v_mul_u32_u24 v7, 3277, v6
  v_lshrrev_b32 v7, 22, v7
  v_mul_u32_u24 v8, 1280, v7
  v_sub_u32 v6, v6, v8
  v_lshlrev_b32 v7, 5, v7
L_hopB_8:
  s_cbranch_execz L_hopB_9
  v_xor_b32 v9, v6, v7
  v_add_u32 v150, v8, v9
  v_xor_b32 v9, 128, v9
  v_add_u32 v155, v8, v9
  v_lshlrev_b32 v6, 4, v5
  v_add_u32 v6, 3072, v6
  v_mul_u32_u24 v7, 3277, v6
  v_lshrrev_b32 v7, 22, v7
  v_mul_u32_u24 v8, 1280, v7
  v_sub_u32 v6, v6, v8
  v_lshlrev_b32 v7, 5, v7
  v_xor_b32 v9, v6, v7
  v_add_u32 v151, v8, v9
  v_xor_b32 v9, 128, v9
L_hopB_9:
  s_cbranch_execz L_hopB_10
  v_add_u32 v156, v8, v9
  v_lshlrev_b32 v6, 4, v5
  v_add_u32 v6, 4096, v6
  v_mul_u32_u24 v7, 3277, v6
  v_lshrrev_b32 v7, 22, v7
  v_mul_u32_u24 v8, 1280, v7
  v_sub_u32 v6, v6, v8
  v_lshlrev_b32 v7, 5, v7
  v_xor_b32 v9, v6, v7
  v_add_u32 v152, v8, v9
  v_xor_b32 v9, 128, v9
  v_add_u32 v157, v8, v9
  s_sub_u32 s63, s44, 10
  s_mul_i32 s48, s63, 20480
L_hopB_10:
  s_cbranch_execz L_hopB_11
  s_add_u32 s49, s48, 111104
  s_mov_b32 m0, s49
  s_add_u32 s49, s49, 1024
  buffer_load_dwordx4 v148, s[32:35], s48 offen nt lds
  s_mov_b32 m0, s49
  s_add_u32 s49, s49, 1024
  buffer_load_dwordx4 v149, s[32:35], s48 offen nt lds
  s_mov_b32 m0, s49
  s_add_u32 s49, s49, 1024
  buffer_load_dwordx4 v150, s[32:35], s48 offen nt lds
  s_mov_b32 m0, s49
  s_add_u32 s49, s49, 1024
  buffer_load_dwordx4 v151, s[32:35], s48 offen nt lds
  s_mov_b32 m0, s49
L_hopB_11:
  s_cbranch_execz L_hopB_12
  s_add_u32 s49, s49, 1024
  buffer_load_dwordx4 v152, s[32:35], s48 offen nt lds
  s_add_u32 s48, s48, 5120
  s_mov_b32 m0, s49
  s_add_u32 s49, s49, 1024
  buffer_load_dwordx4 v148, s[32:35], s48 offen nt lds
  s_mov_b32 m0, s49
  s_add_u32 s49, s49, 1024
  buffer_load_dwordx4 v149, s[32:35], s48 offen nt lds
  s_mov_b32 m0, s49
  s_add_u32 s49, s49, 1024
  buffer_load_dwordx4 v150, s[32:35], s48 offen nt lds
  s_mov_b32 m0, s49
  s_add_u32 s49, s49, 1024
L_hopB_12:
  s_cbranch_execz L_hopB_13
  buffer_load_dwordx4 v151, s[32:35], s48 offen nt lds
  s_mov_b32 m0, s49
  s_add_u32 s49, s49, 1024
  buffer_load_dwordx4 v152, s[32:35], s48 offen nt lds
  s_add_u32 s48, s48, 5120
  s_mov_b32 m0, s49
  s_add_u32 s49, s49, 1024
  buffer_load_dwordx4 v153, s[32:35], s48 offen nt lds
  s_mov_b32 m0, s49
  s_add_u32 s49, s49, 1024
  buffer_load_dwordx4 v154, s[32:35], s48 offen nt lds
  s_mov_b32 m0, s49
  s_add_u32 s49, s49, 1024
  buffer_load_dwordx4 v155, s[32:35], s48 offen nt lds
L_hopB_13:
  s_cbranch_execz L_hopB_14
  s_mov_b32 m0, s49
  s_add_u32 s49, s49, 1024
  buffer_load_dwordx4 v156, s[32:35], s48 offen nt lds
  s_mov_b32 m0, s49
  s_add_u32 s49, s49, 1024
  buffer_load_dwordx4 v157, s[32:35], s48 offen nt lds
  s_add_u32 s48, s48, 5120
  s_mov_b32 m0, s49
  s_add_u32 s49, s49, 1024
  buffer_load_dwordx4 v153, s[32:35], s48 offen nt lds
  s_mov_b32 m0, s49
  s_add_u32 s49, s49, 1024
  buffer_load_dwordx4 v154, s[32:35], s48 offen nt lds
  s_mov_b32 m0, s49
L_hopB_14:
  s_cbranch_execz L_hopB_15
  s_add_u32 s49, s49, 1024
  buffer_load_dwordx4 v155, s[32:35], s48 offen nt lds
  s_mov_b32 m0, s49
  s_add_u32 s49, s49, 1024
  buffer_load_dwordx4 v156, s[32:35], s48 offen nt lds
  s_mov_b32 m0, s49
  s_add_u32 s49, s49, 1024
  buffer_load_dwordx4 v157, s[32:35], s48 offen nt lds
  s_waitcnt vmcnt(20)
L_gu_dma_done:
  s_nop 1
  v_max3_u32 v6, v12, v13, v14
  v_max3_u32 v6, v6, v15, v16
  v_max_u32 v6, v6, v17
  v_cmp_eq_u32 vcc, -1, v6
L_hopB_15:
  s_cbranch_execz L_hopB_16
  s_cmp_eq_u64 vcc, 0
  s_cbranch_scc1 L_pm2_skip
  s_mov_b32 s62, 0
L_pm2:
  buffer_load_dwordx2 v[12:13], v40, s[40:43], s85 offen sc1
  buffer_load_dwordx2 v[14:15], v41, s[40:43], s85 offen sc1
  buffer_load_dwordx2 v[16:17], v42, s[40:43], s85 offen sc1
  s_add_u32 s62, s62, 1
  s_waitcnt vmcnt(0)
  v_max3_u32 v6, v12, v13, v14
  v_max3_u32 v6, v6, v15, v16
  v_max_u32 v6, v6, v17
  v_cmp_eq_u32 vcc, -1, v6
  s_cmp_eq_u64 vcc, 0
  s_cbranch_scc1 L_pm2_ok
L_hopB_16:
  s_cbranch_execz L_hopB_17
  s_cmp_lt_u32 s62, 65536
  s_cbranch_scc1 L_pm2
L_pm2_ok:
L_pm2_skip:
  v_lshlrev_b32 v20, 16, v16
  v_and_b32 v21, 0xffff0000, v16
  v_lshlrev_b32 v22, 16, v17
  v_and_b32 v23, 0xffff0000, v17
  v_add_f32 v20, 1.0, v20
  v_add_f32 v21, 1.0, v21
  v_add_f32 v22, 1.0, v22
  v_add_f32 v23, 1.0, v23
  v_cvt_pk_bf16_f32 v6, v20, v21
  v_lshlrev_b32 v20, 16, v6
  v_and_b32 v21, 0xffff0000, v6
  v_cvt_pk_bf16_f32 v6, v22, v23
L_hopB_17:
  s_cbranch_execz L_hopB_18
  v_lshlrev_b32 v22, 16, v6
  v_and_b32 v23, 0xffff0000, v6
  v_lshlrev_b32 v24, 16, v14
  v_and_b32 v25, 0xffff0000, v14
  v_lshlrev_b32 v26, 16, v15
  v_and_b32 v27, 0xffff0000, v15
  v_lshlrev_b32 v84, 16, v12
  v_and_b32 v85, 0xffff0000, v12
  v_lshlrev_b32 v86, 16, v13
  v_and_b32 v87, 0xffff0000, v13
  v_lshlrev_b32 v88, 16, v18
  v_and_b32 v89, 0xffff0000, v18
  v_lshlrev_b32 v90, 16, v19
  v_and_b32 v91, 0xffff0000, v19
L_hopB_18:
  s_cbranch_execz L_hopB_19
  v_lshrrev_b32 v6, 4, v5
  v_bfe_u32 v7, v5, 2, 2
  v_lshl_add_u32 v28, v6, 3, v7
  v_lshlrev_b32 v28, 6, v28
  v_and_b32 v6, 1, v6
  v_lshl_or_b32 v28, v6, 5, v28
  v_and_b32 v6, 3, v5
  v_lshl_add_u32 v28, v6, 3, v28
  s_and_b32 s45, s44, 1
  s_lshl_b32 s45, s45, 5
  v_xor_b32 v28, s45, v28
  s_bfe_u32 s45, s44, 0x10001
  s_mul_i32 s45, s45, 40960
  s_lshr_b32 s46, s44, 2
L_hopB_19:
  s_cbranch_execz L_hopB_20
  s_mul_i32 s47, s46, 14336
  s_add_u32 s45, s45, s47
  s_add_u32 s45, s45, 29184
  v_add_u32 v28, s45, v28
  v_and_b32 v6, 3, v5
  v_mul_u32_u24 v29, 1344, v6
  v_lshrrev_b32 v6, 4, v5
  v_lshl_add_u32 v29, v6, 4, v29
  s_mul_i32 s47, s46, 448
  s_add_u32 s47, s47, 0
  v_add_u32 v29, s47, v29
  v_lshrrev_b32 v30, 4, v5
  v_and_b32 v6, 3, v5
  v_lshl_add_u32 v30, v30, 2, v6
L_hopB_20:
  s_cbranch_execz L_hopB_21
  v_lshlrev_b32 v30, 4, v30
  s_mul_i32 s47, s87, 1344
  s_add_u32 s47, s47, 0
  v_lshl_add_u32 v31, v10, 3, s47
  s_mul_i32 s45, s87, 1280
  s_add_u32 s45, s45, 23040
  v_lshl_add_u32 v92, v10, 3, s45
  s_cmp_eq_u32 s88, 2
  s_mov_b32 s45, 0x3b9d89d9
  s_cselect_b32 s45, s45, 0x3b97b426
  v_mov_b32 v93, s45
  s_lshl_b32 s45, s44, 3
  s_add_u32 s45, s45, 17728
  v_mov_b32 v94, s45
L_hopB_21:
  s_cbranch_execz L_hopB_22
  s_mul_i32 s45, s87, 24
  s_add_u32 s45, s45, 17728
  v_mov_b32 v95, s45
  s_cmp_ge_u32 s44, 10
  s_cbranch_scc1 L_gu_nowait
  s_waitcnt vmcnt(0)
L_gu_nowait:
  s_barrier
  ds_read_b64_tr_b16 v[96:97], v28 offset:0
  ds_read_b64_tr_b16 v[98:99], v28 offset:256
  ds_read_b64_tr_b16 v[100:101], v28 offset:2048
  ds_read_b64_tr_b16 v[102:103], v28 offset:2304
  ds_read_b64_tr_b16 v[104:105], v28 offset:4096
  ds_read_b64_tr_b16 v[106:107], v28 offset:4352
  ds_read_b64_tr_b16 v[108:109], v28 offset:6144
L_hopB_22:
  s_cbranch_execz L_hopB_23
  ds_read_b64_tr_b16 v[110:111], v28 offset:6400
  ds_read_b64_tr_b16 v[112:113], v28 offset:8192
  ds_read_b64_tr_b16 v[114:115], v28 offset:8448
  ds_read_b64_tr_b16 v[116:117], v28 offset:10240
  ds_read_b64_tr_b16 v[118:119], v28 offset:10496
  ds_read_b64_tr_b16 v[120:121], v28 offset:12288
  ds_read_b64_tr_b16 v[122:123], v28 offset:12544
  v_lshrrev_b32 v6, 4, v5
  v_bfe_u32 v7, v5, 2, 2
  v_lshl_add_u32 v8, v6, 3, v7
  v_mul_u32_u24 v8, 1280, v8
  v_and_b32 v9, 3, v5
  v_lshl_add_u32 v8, v9, 3, v8
  v_add_u32 v8, 111104, v8
L_hopB_23:
  s_cbranch_execz L_hopB_24
  v_and_b32 v6, 1, v6
  v_lshl_or_b32 v7, v6, 2, v7
  v_lshlrev_b32 v7, 5, v7
  s_add_u32 s45, s44, 0
  s_lshl_b32 s45, s45, 5
  v_xor_b32 v9, s45, v7
  v_add_u32 v158, v8, v9
  s_add_u32 s45, s44, 12
  s_lshl_b32 s45, s45, 5
  v_xor_b32 v9, s45, v7
  v_add_u32 v159, v8, v9
  s_add_u32 s45, s44, 24
  s_lshl_b32 s45, s45, 5
  v_xor_b32 v9, s45, v7
L_hopB_24:
  s_cbranch_execz L_hopB_25
  v_add_u32 v160, v8, v9
  s_add_u32 s45, s44, 36
  s_lshl_b32 s45, s45, 5
  v_xor_b32 v9, s45, v7
  v_add_u32 v161, v8, v9
  s_mov_b32 s63, 255
  s_mov_b32 s62, 0
L_py:
  s_bitcmp1_b32 s63, 0
  s_cbranch_scc0 L_py_s0
  buffer_load_dwordx4 v[48:51], v140, s[40:43], s86 offen sc1
L_py_s0:
  s_bitcmp1_b32 s63, 1
  s_cbranch_scc0 L_py_s1
  buffer_load_dwordx4 v[52:55], v141, s[40:43], s86 offen sc1
L_py_s1:
  s_bitcmp1_b32 s63, 2
L_hopB_25:
  s_cbranch_execz L_hopB_26
  s_cbranch_scc0 L_py_s2
  buffer_load_dwordx4 v[56:59], v142, s[40:43], s86 offen sc1
L_py_s2:
  s_bitcmp1_b32 s63, 3
  s_cbranch_scc0 L_py_s3
  buffer_load_dwordx4 v[60:63], v143, s[40:43], s86 offen sc1
L_py_s3:
  s_bitcmp1_b32 s63, 4
  s_cbranch_scc0 L_py_s4
  buffer_load_dwordx4 v[64:67], v144, s[40:43], s86 offen sc1
L_py_s4:
  s_bitcmp1_b32 s63, 5
  s_cbranch_scc0 L_py_s5
  buffer_load_dwordx4 v[68:71], v145, s[40:43], s86 offen sc1
L_py_s5:
  s_bitcmp1_b32 s63, 6
  s_cbranch_scc0 L_py_s6
  buffer_load_dwordx4 v[72:75], v146, s[40:43], s86 offen sc1
L_py_s6:
L_hopB_26:
  s_cbranch_execz L_hopB_27
  s_bitcmp1_b32 s63, 7
  s_cbranch_scc0 L_py_s7
  buffer_load_dwordx4 v[76:79], v147, s[40:43], s86 offen sc1
L_py_s7:
L_py_chk:
  s_add_u32 s62, s62, 1
  s_waitcnt vmcnt(0)
  v_max3_u32 v6, v48, v49, v50
  v_max_u32 v6, v6, v51
  v_cmp_eq_u32 vcc, -1, v6
  s_cmp_eq_u64 vcc, 0
  s_cbranch_scc0 L_py_p0
  s_bitset0_b32 s63, 0
L_py_p0:
  v_max3_u32 v6, v52, v53, v54
  v_max_u32 v6, v6, v55
  v_cmp_eq_u32 vcc, -1, v6
L_hopB_27:
  s_cbranch_execz L_hopB_28
  s_cmp_eq_u64 vcc, 0
  s_cbranch_scc0 L_py_p1
  s_bitset0_b32 s63, 1
L_py_p1:
  v_max3_u32 v6, v56, v57, v58
  v_max_u32 v6, v6, v59
  v_cmp_eq_u32 vcc, -1, v6
  s_cmp_eq_u64 vcc, 0
  s_cbranch_scc0 L_py_p2
  s_bitset0_b32 s63, 2
L_py_p2:
  v_max3_u32 v6, v60, v61, v62
  v_max_u32 v6, v6, v63
  v_cmp_eq_u32 vcc, -1, v6
  s_cmp_eq_u64 vcc, 0
  s_cbranch_scc0 L_py_p3
L_hopB_28:
  s_cbranch_execz L_hopB_29
  s_bitset0_b32 s63, 3
L_py_p3:
  v_max3_u32 v6, v64, v65, v66
  v_max_u32 v6, v6, v67
  v_cmp_eq_u32 vcc, -1, v6
  s_cmp_eq_u64 vcc, 0
  s_cbranch_scc0 L_py_p4
  s_bitset0_b32 s63, 4
L_py_p4:
  v_max3_u32 v6, v68, v69, v70
  v_max_u32 v6, v6, v71
  v_cmp_eq_u32 vcc, -1, v6
  s_cmp_eq_u64 vcc, 0
  s_cbranch_scc0 L_py_p5
  s_bitset0_b32 s63, 5
L_py_p5:
  v_max3_u32 v6, v72, v73, v74
L_hopB_29:
  s_cbranch_execz L_hopB_30
  v_max_u32 v6, v6, v75
  v_cmp_eq_u32 vcc, -1, v6
  s_cmp_eq_u64 vcc, 0
  s_cbranch_scc0 L_py_p6
  s_bitset0_b32 s63, 6
L_py_p6:
  v_max3_u32 v6, v76, v77, v78
  v_max_u32 v6, v6, v79
  v_cmp_eq_u32 vcc, -1, v6
  s_cmp_eq_u64 vcc, 0
  s_cbranch_scc0 L_py_p7
  s_bitset0_b32 s63, 7
L_py_p7:
  s_cmp_eq_u32 s63, 0
  s_cbranch_scc1 L_py_ok
  s_cmp_lt_u32 s62, 65536
L_hopB_30:
  s_cbranch_execz L_hopB_31
  s_cbranch_scc1 L_py
L_py_ok:
  v_pk_add_f32 v[48:49], v[48:49], v[52:53]
  v_pk_add_f32 v[50:51], v[50:51], v[54:55]
  v_pk_add_f32 v[56:57], v[56:57], v[60:61]
  v_pk_add_f32 v[58:59], v[58:59], v[62:63]
  v_pk_add_f32 v[64:65], v[64:65], v[68:69]
  v_pk_add_f32 v[66:67], v[66:67], v[70:71]
  v_pk_add_f32 v[72:73], v[72:73], v[76:77]
  v_pk_add_f32 v[74:75], v[74:75], v[78:79]
  v_pk_add_f32 v[48:49], v[48:49], v[56:57]
  v_pk_add_f32 v[50:51], v[50:51], v[58:59]
  v_pk_add_f32 v[64:65], v[64:65], v[72:73]
  v_pk_add_f32 v[66:67], v[66:67], v[74:75]
  v_pk_add_f32 v[40:41], v[48:49], v[64:65]
L_hopB_31:
  s_cbranch_execz L_hopB_32
  v_pk_add_f32 v[42:43], v[50:51], v[66:67]
  v_cvt_pk_bf16_f32 v6, v40, v41
  v_lshlrev_b32 v40, 16, v6
  v_and_b32 v41, 0xffff0000, v6
  v_cvt_pk_bf16_f32 v6, v42, v43
  v_lshlrev_b32 v42, 16, v6
  v_and_b32 v43, 0xffff0000, v6
  v_pk_mul_f32 v[40:41], v[40:41], v[84:85]
  v_pk_mul_f32 v[42:43], v[42:43], v[86:87]
  v_cvt_pk_bf16_f32 v6, v40, v41
  v_lshlrev_b32 v40, 16, v6
  v_and_b32 v41, 0xffff0000, v6
  v_cvt_pk_bf16_f32 v6, v42, v43
  v_lshlrev_b32 v42, 16, v6
L_hopB_32:
  s_cbranch_execz L_hopB_33
  v_and_b32 v43, 0xffff0000, v6
  v_pk_add_f32 v[40:41], v[40:41], v[88:89]
  v_pk_add_f32 v[42:43], v[42:43], v[90:91]
  v_cvt_pk_bf16_f32 v36, v40, v41
  v_cvt_pk_bf16_f32 v37, v42, v43
  v_lshlrev_b32 v32, 16, v36
  v_and_b32 v33, 0xffff0000, v36
  v_lshlrev_b32 v34, 16, v37
  v_and_b32 v35, 0xffff0000, v37
  s_mov_b64 exec, s[50:51]
  ds_write_b64 v92, v[36:37]
  s_mov_b64 exec, -1
  v_readfirstlane_b32 s46, v32
  s_nop 1
  v_subrev_f32 v40, s46, v32
L_hopB_33:
  s_cbranch_execz L_hopB_34
  v_subrev_f32 v41, s46, v33
  v_subrev_f32 v42, s46, v34
  v_subrev_f32 v43, s46, v35
  v_add_f32 v36, v40, v41
  v_mul_f32 v37, v40, v40
  v_add_f32 v38, v42, v43
  v_fmac_f32 v37, v41, v41
  v_add_f32 v36, v36, v38
  v_fmac_f32 v37, v42, v42
  v_fmac_f32 v37, v43, v43
  v_cndmask_b32 v36, 0, v36, s[50:51]
  v_cndmask_b32 v37, 0, v37, s[50:51]
  s_nop 0
  v_add_f32_dpp v36, v36, v36 row_ror:8 row_mask:0xf bank_mask:0xf
  v_add_f32_dpp v37, v37, v37 row_ror:8 row_mask:0xf bank_mask:0xf
L_hopB_34:
  s_cbranch_execz L_hopB_35
  v_add_f32_dpp v36, v36, v36 row_ror:4 row_mask:0xf bank_mask:0xf
  v_add_f32_dpp v37, v37, v37 row_ror:4 row_mask:0xf bank_mask:0xf
  s_nop 0
  v_add_f32_dpp v36, v36, v36 row_ror:2 row_mask:0xf bank_mask:0xf
  v_add_f32_dpp v37, v37, v37 row_ror:2 row_mask:0xf bank_mask:0xf
  s_nop 0
  v_add_f32_dpp v36, v36, v36 row_ror:1 row_mask:0xf bank_mask:0xf
  v_add_f32_dpp v37, v37, v37 row_ror:1 row_mask:0xf bank_mask:0xf
  s_nop 0
  v_add_f32_dpp v36, v36, v36 row_bcast:15 row_mask:0xa bank_mask:0xf
  v_add_f32_dpp v37, v37, v37 row_bcast:15 row_mask:0xa bank_mask:0xf
  s_nop 0
  v_add_f32_dpp v36, v36, v36 row_bcast:31 row_mask:0xc bank_mask:0xf
  v_add_f32_dpp v37, v37, v37 row_bcast:31 row_mask:0xc bank_mask:0xf
  v_readlane_b32 s47, v36, 63
  v_readlane_b32 s45, v37, 63
  s_nop 0
  v_mul_f32 v38, s47, v93
  v_mov_b32 v39, s45
L_hopB_35:
  s_cbranch_execz L_hopB_36
  v_add_f32 v37, s46, v38
  v_mul_f32 v38, s47, v38
  v_sub_f32 v38, v39, v38
  ds_write_b32 v94, v37
  ds_write_b32 v94, v38 offset:4
  s_waitcnt lgkmcnt(0)
  s_barrier
  ds_read_b64 v[40:41], v95
  ds_read_b64 v[42:43], v95 offset:8
  ds_read_b64 v[44:45], v95 offset:16
  ds_read_b64_tr_b16 v[124:125], v158
  ds_read_b64_tr_b16 v[126:127], v158 offset:5120
  ds_read_b64_tr_b16 v[128:129], v159
  ds_read_b64_tr_b16 v[130:131], v159 offset:5120
L_hopB_36:
  s_cbranch_execz L_hopB_37
  ds_read_b64_tr_b16 v[132:133], v160
  ds_read_b64_tr_b16 v[134:135], v160 offset:5120
  ds_read_b64_tr_b16 v[136:137], v161
  ds_read_b64_tr_b16 v[138:139], v161 offset:5120
  s_waitcnt lgkmcnt(8)
  v_add_f32 v46, v40, v42
  v_mov_b32 v47, 0x43500000
  v_mul_f32 v46, 0x43580000, v46
  v_add_f32 v41, v41, v43
  v_fmac_f32 v46, v47, v44
  v_add_f32 v41, v41, v45
  v_mul_f32 v46, 0x3acccccd, v46
  v_sub_f32 v40, v40, v46
  v_sub_f32 v42, v42, v46
L_hopB_37:
  s_cbranch_execz L_hopB_38
  v_sub_f32 v44, v44, v46
  v_cvt_pk_bf16_f32 v52, v46, v46
  v_mul_f32 v40, v40, v40
  v_mul_f32 v44, v44, v44
  v_lshlrev_b32 v52, 16, v52
  v_fmac_f32 v40, v42, v42
  v_mov_b32 v53, v52
  v_mul_f32 v40, 0x43580000, v40
  v_pk_add_f32 v[32:33], v[32:33], v[52:53] neg_lo:[0,1] neg_hi:[0,1]
  v_fmac_f32 v40, v47, v44
  v_pk_add_f32 v[34:35], v[34:35], v[52:53] neg_lo:[0,1] neg_hi:[0,1]
  v_add_f32 v40, v40, v41
  v_cvt_pk_bf16_f32 v6, v32, v33
  v_mul_f32 v40, 0x3acccccd, v40
L_hopB_38:
  s_cbranch_execz L_hopB_39
  v_cvt_pk_bf16_f32 v7, v34, v35
  v_cvt_pk_bf16_f32 v48, v40, v40
  v_lshlrev_b32 v32, 16, v6
  v_lshlrev_b32 v40, 16, v48
  v_and_b32 v33, 0xffff0000, v6
  v_add_f32 v40, 0x3727c5ac, v40
  v_lshlrev_b32 v34, 16, v7
  v_cvt_pk_bf16_f32 v48, v40, v40
  v_and_b32 v35, 0xffff0000, v7
  v_lshlrev_b32 v40, 16, v48
  v_sqrt_f32 v48, v40
  v_rcp_f32 v49, v48
  v_fma_f32 v50, -v48, v48, v40
  v_mul_f32 v49, 0.5, v49
L_hopB_39:
  s_cbranch_execz L_hopB_40
  v_fma_f32 v48, v50, v49, v48
  v_cvt_pk_bf16_f32 v48, v48, v48
  v_lshlrev_b32 v40, 16, v48
  v_rcp_f32 v42, v40
  v_mov_b32 v41, v40
  v_mov_b32 v43, v42
  v_pk_mul_f32 v[48:49], v[32:33], v[42:43]
  v_pk_mul_f32 v[50:51], v[34:35], v[42:43]
  v_pk_fma_f32 v[32:33], v[48:49], v[40:41], v[32:33] neg_lo:[1,0,0] neg_hi:[1,0,0]
  v_pk_fma_f32 v[34:35], v[50:51], v[40:41], v[34:35] neg_lo:[1,0,0] neg_hi:[1,0,0]
  v_pk_fma_f32 v[32:33], v[32:33], v[42:43], v[48:49]
  v_pk_fma_f32 v[34:35], v[34:35], v[42:43], v[50:51]
  v_cvt_pk_bf16_f32 v6, v32, v33
  v_lshlrev_b32 v32, 16, v6
L_hopB_40:
  s_cbranch_execz L_hopB_41
  v_and_b32 v33, 0xffff0000, v6
  v_cvt_pk_bf16_f32 v6, v34, v35
  v_lshlrev_b32 v34, 16, v6
  v_and_b32 v35, 0xffff0000, v6
  v_pk_mul_f32 v[32:33], v[32:33], v[20:21]
  v_pk_mul_f32 v[34:35], v[34:35], v[22:23]
  v_cvt_pk_bf16_f32 v6, v32, v33
  v_lshlrev_b32 v32, 16, v6
  v_and_b32 v33, 0xffff0000, v6
  v_cvt_pk_bf16_f32 v6, v34, v35
  v_lshlrev_b32 v34, 16, v6
  v_and_b32 v35, 0xffff0000, v6
  v_pk_add_f32 v[32:33], v[32:33], v[24:25]
  v_pk_add_f32 v[34:35], v[34:35], v[26:27]
L_hopB_41:
  s_cbranch_execz L_hopB_42
  v_cvt_pk_bf16_f32 v32, v32, v33
  v_cvt_pk_bf16_f32 v33, v34, v35
  s_mov_b64 exec, s[50:51]
  ds_write_b64 v31, v[32:33]
  s_mov_b64 exec, -1
  s_waitcnt lgkmcnt(0)
  s_barrier
  s_cmp_ge_u32 s44, 8
  s_cbranch_scc1 L_gu_m6
  ds_read_b128 v[40:43], v29 offset:0
  ds_read_b128 v[44:47], v29 offset:64
  ds_read_b128 v[48:51], v29 offset:128
  ds_read_b128 v[52:55], v29 offset:192
  ds_read_b128 v[56:59], v29 offset:256
L_hopB_42:
  s_cbranch_execz L_hopB_43
  ds_read_b128 v[60:63], v29 offset:320
  ds_read_b128 v[64:67], v29 offset:384
  s_waitcnt lgkmcnt(6)
  v_mfma_f32_16x16x32_bf16 v[20:23], v[96:99], v[40:43], 0
  s_waitcnt lgkmcnt(5)
  v_mfma_f32_16x16x32_bf16 v[20:23], v[100:103], v[44:47], v[20:23]
  s_waitcnt lgkmcnt(4)
  v_mfma_f32_16x16x32_bf16 v[20:23], v[104:107], v[48:51], v[20:23]
  s_waitcnt lgkmcnt(3)
  v_mfma_f32_16x16x32_bf16 v[20:23], v[108:111], v[52:55], v[20:23]
  s_waitcnt lgkmcnt(2)
  v_mfma_f32_16x16x32_bf16 v[20:23], v[112:115], v[56:59], v[20:23]
  s_waitcnt lgkmcnt(1)
  v_mfma_f32_16x16x32_bf16 v[20:23], v[116:119], v[60:63], v[20:23]
L_hopB_43:
  s_cbranch_execz L_hopB_44
  s_waitcnt lgkmcnt(0)
  v_mfma_f32_16x16x32_bf16 v[20:23], v[120:123], v[64:67], v[20:23]
  s_branch L_gu_mdone
L_gu_m6:
  s_nop 1
  ds_read_b128 v[40:43], v29 offset:0
  ds_read_b128 v[44:47], v29 offset:64
  ds_read_b128 v[48:51], v29 offset:128
  ds_read_b128 v[52:55], v29 offset:192
  ds_read_b128 v[56:59], v29 offset:256
  ds_read_b128 v[60:63], v29 offset:320
  s_waitcnt lgkmcnt(5)
  v_mfma_f32_16x16x32_bf16 v[20:23], v[96:99], v[40:43], 0
  s_waitcnt lgkmcnt(4)
  v_mfma_f32_16x16x32_bf16 v[20:23], v[100:103], v[44:47], v[20:23]
L_hopB_44:
  s_cbranch_execz L_hopB_45
  s_waitcnt lgkmcnt(3)
  v_mfma_f32_16x16x32_bf16 v[20:23], v[104:107], v[48:51], v[20:23]
  s_waitcnt lgkmcnt(2)
  v_mfma_f32_16x16x32_bf16 v[20:23], v[108:111], v[52:55], v[20:23]
  s_waitcnt lgkmcnt(1)
  v_mfma_f32_16x16x32_bf16 v[20:23], v[112:115], v[56:59], v[20:23]
  s_waitcnt lgkmcnt(0)
  v_mfma_f32_16x16x32_bf16 v[20:23], v[116:119], v[60:63], v[20:23]
L_gu_mdone:
  s_nop 7
  s_lshl_b32 s45, s44, 8
  s_add_u32 s45, s45, 12800
  v_add_u32 v30, s45, v30
  s_mov_b32 exec_lo, 0xf000f
  s_mov_b32 exec_hi, 0xf000f
L_hopB_45:
  s_cbranch_execz L_hopB_46
  ds_write_b128 v30, v[20:23]
  s_mov_b64 exec, -1
  s_waitcnt lgkmcnt(0)
  s_barrier
  s_cmp_lg_u32 s44, 0
  s_cbranch_scc1 L_gu_done
  v_lshlrev_b32 v6, 4, v5
  ds_read_b128 v[20:23], v6 offset:12800
  ds_read_b128 v[24:27], v6 offset:13824
  ds_read_b128 v[28:31], v6 offset:14848
  s_waitcnt lgkmcnt(0)
  v_add_f32 v20, v20, v24
  v_add_f32 v21, v21, v25
  v_add_f32 v22, v22, v26
L_hopB_46:
  s_cbranch_execz L_hopB_47
  v_add_f32 v23, v23, v27
  v_add_f32 v20, v20, v28
  v_add_f32 v21, v21, v29
  v_add_f32 v22, v22, v30
  v_add_f32 v23, v23, v31
  v_cvt_pk_bf16_f32 v6, v20, v21
  v_lshlrev_b32 v20, 16, v6
  v_and_b32 v21, 0xffff0000, v6
  v_cvt_pk_bf16_f32 v6, v22, v23
  v_lshlrev_b32 v22, 16, v6
  v_and_b32 v23, 0xffff0000, v6
  v_mov_b32 v24, v20
  v_mov_b32 v25, v21
  v_mov_b32 v26, v22
L_hopB_47:
  s_cbranch_execz L_hopB_48
  v_mov_b32 v27, v23
  v_permlane32_swap_b32 v20, v24
  v_permlane32_swap_b32 v21, v25
  v_permlane32_swap_b32 v22, v26
  v_permlane32_swap_b32 v23, v27
  v_mul_f32 v20, v20, v24
  v_mul_f32 v21, v21, v25
  v_mul_f32 v22, v22, v26
  v_mul_f32 v23, v23, v27
  v_cvt_pk_bf16_f32 v20, v20, v21
  v_cvt_pk_bf16_f32 v21, v22, v23
  v_and_b32 v6, 3, v5
  v_lshlrev_b32 v6, 6, v6
  v_bfe_u32 v7, v5, 2, 3
L_hopB_48:
  s_cbranch_execz L_hopB_49
  v_lshl_add_u32 v6, v7, 3, v6
  s_mov_b32 exec_lo, -1
  s_mov_b32 exec_hi, 0
  ds_write_b64 v6, v[20:21] offset:16896
  s_mov_b64 exec, -1
  s_waitcnt lgkmcnt(0)
L_gu_done:
  s_barrier
  v_and_b32 v6, 3, v5
  v_lshlrev_b32 v6, 6, v6
  v_lshrrev_b32 v7, 4, v5
  v_lshl_add_u32 v6, v7, 4, v6
  ds_read_b128 v[40:43], v6 offset:16896
  v_and_b32 v6, 3, v5
  v_lshlrev_b32 v6, 6, v6
L_hopB_49:
  s_cbranch_execz L_hopB_50
  v_lshl_add_u32 v6, v7, 4, v6
  s_mul_i32 s45, s44, 12288
  s_lshl_b32 s46, s83, 8
  s_add_u32 s45, s45, s46
  s_add_u32 s45, s45, 540672
  s_waitcnt lgkmcnt(0)
  v_mfma_f32_16x16x32_bf16 v[44:47], v[124:127], v[40:43], 0
  v_mfma_f32_16x16x32_bf16 v[48:51], v[128:131], v[40:43], 0
  v_mfma_f32_16x16x32_bf16 v[52:55], v[132:135], v[40:43], 0
  v_mfma_f32_16x16x32_bf16 v[56:59], v[136:139], v[40:43], 0
  s_mov_b32 exec_lo, 0xf000f
  s_mov_b32 exec_hi, 0xf000f
  s_nop 2
  v_min_u32 v44, -2, v44
  v_min_u32 v45, -2, v45
L_hopB_50:
  s_cbranch_execz L_hopB_51
  v_min_u32 v46, -2, v46
  v_min_u32 v47, -2, v47
  buffer_store_dwordx4 v[44:47], v6, s[40:43], s45 offen sc1
  s_add_u32 s45, s45, 147456
  v_min_u32 v48, -2, v48
  v_min_u32 v49, -2, v49
  v_min_u32 v50, -2, v50
  v_min_u32 v51, -2, v51
  buffer_store_dwordx4 v[48:51], v6, s[40:43], s45 offen sc1
  s_add_u32 s45, s45, 147456
  v_min_u32 v52, -2, v52
  v_min_u32 v53, -2, v53
  v_min_u32 v54, -2, v54
  v_min_u32 v55, -2, v55
L_hopB_51:
  s_cbranch_execz L_hopB_52
  buffer_store_dwordx4 v[52:55], v6, s[40:43], s45 offen sc1
  s_add_u32 s45, s45, 147456
  s_cmp_ge_u32 s44, 4
  s_cbranch_scc1 L_gu_st_done
  v_min_u32 v56, -2, v56
  v_min_u32 v57, -2, v57
  v_min_u32 v58, -2, v58
  v_min_u32 v59, -2, v59
  buffer_store_dwordx4 v[56:59], v6, s[40:43], s45 offen sc1
L_gu_st_done:
  s_mov_b64 exec, -1
  s_cmp_lt_u32 s92, 40
  s_cbranch_scc0 L_tail
L_hopB_52:
  s_cbranch_execz L_warm_ret
L_hopC_0:
  s_cbranch_execz L_hopC_1
  s_nop 1
  v_lshlrev_b32 v10, 4, v5
  s_mul_i32 s47, s92, 12288
  s_lshl_b32 s45, s44, 10
  s_add_u32 s47, s47, s45
  s_add_u32 s47, s47, 540672
  v_bfe_u32 v12, v5, 2, 2
  v_and_b32 v13, 3, v5
  v_mul_u32_u24 v14, 7680, v12
  v_lshl_add_u32 v14, v13, 3, v14
  s_lshl_b32 s45, s92, 5
  s_add_u32 s46, s45, 6400
  v_mul_u32_u24 v31, 1280, v12
  v_lshl_add_u32 v31, v13, 3, v31
L_hopC_1:
  s_cbranch_execz L_hopC_2
  s_add_u32 s45, s45, 23040
  v_add_u32 v31, s45, v31
  v_and_b32 v30, 15, v5
  v_lshlrev_b32 v30, 4, v30
  s_lshl_b32 s45, s44, 8
  s_add_u32 s45, s45, 12800
  v_add_u32 v29, s45, v30
  s_mov_b32 s62, 0
L_ph:
  buffer_load_dwordx4 v[40:43], v10, s[40:43], s47 offen sc1
  buffer_load_dwordx2 v[22:23], v14, s[40:43], s46 offen sc1
  s_add_u32 s62, s62, 1
  s_waitcnt vmcnt(0)
  v_max3_u32 v6, v40, v41, v42
  v_max3_u32 v6, v6, v43, v22
L_hopC_2:
  s_cbranch_execz L_hopC_3
  v_max_u32 v6, v6, v23
  v_cmp_eq_u32 vcc, -1, v6
  s_cmp_eq_u64 vcc, 0
  s_cbranch_scc1 L_ph_ok
  s_cmp_lt_u32 s62, 65536
  s_cbranch_scc1 L_ph
L_ph_ok:
  v_mov_b32 v44, v40
  v_mov_b32 v45, v41
  v_mov_b32 v46, v42
  v_mov_b32 v47, v43
  v_permlane32_swap_b32 v40, v44
  v_permlane32_swap_b32 v41, v45
  v_permlane32_swap_b32 v42, v46
  v_permlane32_swap_b32 v43, v47
L_hopC_3:
  s_cbranch_execz L_hopC_4
  v_add_f32 v40, v40, v44
  v_add_f32 v41, v41, v45
  v_add_f32 v42, v42, v46
  v_add_f32 v43, v43, v47
  v_mov_b32 v44, v40
  v_mov_b32 v45, v41
  v_mov_b32 v46, v42
  v_mov_b32 v47, v43
  v_permlane16_swap_b32 v40, v44
  v_permlane16_swap_b32 v41, v45
  v_permlane16_swap_b32 v42, v46
  v_permlane16_swap_b32 v43, v47
  v_add_f32 v40, v40, v44
  v_add_f32 v41, v41, v45
L_hopC_4:
  s_cbranch_execz L_hopC_5
  v_add_f32 v42, v42, v46
  v_add_f32 v43, v43, v47
  s_mov_b32 exec_lo, 0xffff
  s_mov_b32 exec_hi, 0
  ds_write_b128 v29, v[40:43]
  s_mov_b64 exec, -1
  s_waitcnt lgkmcnt(0)
  s_barrier
  s_cmp_lg_u32 s44, 0
  s_cbranch_scc1 L_dn_done
  v_lshrrev_b32 v6, 4, v5
  v_mul_u32_u24 v6, 768, v6
  v_add_u32 v6, v6, v30
  ds_read_b128 v[40:43], v6 offset:12800
L_hopC_5:
  s_cbranch_execz L_hopC_6
  ds_read_b128 v[44:47], v6 offset:13056
  ds_read_b128 v[48:51], v6 offset:13312
  ds_read_b64 v[32:33], v31
  s_mov_b32 s36, s26
  s_mov_b32 s37, s27
  s_mov_b32 s38, 5120
  s_mov_b32 s39, 0x20000
  s_waitcnt lgkmcnt(0)
  v_add_f32 v40, v40, v44
  v_add_f32 v41, v41, v45
  v_add_f32 v42, v42, v46
  v_add_f32 v43, v43, v47
  v_add_f32 v40, v40, v48
  v_add_f32 v41, v41, v49
L_hopC_6:
  s_cbranch_execz L_hopC_7
  v_add_f32 v42, v42, v50
  v_add_f32 v43, v43, v51
  v_mov_b32 v44, v40
  v_mov_b32 v45, v41
  v_mov_b32 v46, v42
  v_mov_b32 v47, v43
  v_permlane32_swap_b32 v40, v44
  v_permlane32_swap_b32 v41, v45
  v_permlane32_swap_b32 v42, v46
  v_permlane32_swap_b32 v43, v47
  v_add_f32 v40, v40, v44
  v_add_f32 v41, v41, v45
  v_add_f32 v42, v42, v46
  v_add_f32 v43, v43, v47
L_hopC_7:
  s_cbranch_execz L_hopC_8
  v_mov_b32 v44, v40
  v_mov_b32 v45, v41
  v_mov_b32 v46, v42
  v_mov_b32 v47, v43
  v_permlane16_swap_b32 v40, v44
  v_permlane16_swap_b32 v41, v45
  v_permlane16_swap_b32 v42, v46
  v_permlane16_swap_b32 v43, v47
  v_add_f32 v40, v40, v44
  v_add_f32 v41, v41, v45
  v_add_f32 v42, v42, v46
  v_add_f32 v43, v43, v47
  v_cvt_pk_bf16_f32 v6, v40, v41
  v_lshlrev_b32 v40, 16, v6
L_hopC_8:
  s_cbranch_execz L_hopC_9
  v_and_b32 v41, 0xffff0000, v6
  v_cvt_pk_bf16_f32 v6, v42, v43
  v_lshlrev_b32 v42, 16, v6
  v_and_b32 v43, 0xffff0000, v6
  v_lshlrev_b32 v24, 16, v22
  v_and_b32 v25, 0xffff0000, v22
  v_lshlrev_b32 v26, 16, v23
  v_and_b32 v27, 0xffff0000, v23
  v_mul_f32 v40, v40, v24
  v_mul_f32 v41, v41, v25
  v_mul_f32 v42, v42, v26
  v_mul_f32 v43, v43, v27
  v_cvt_pk_bf16_f32 v6, v40, v41
  v_lshlrev_b32 v40, 16, v6
L_hopC_9:
  s_cbranch_execz L_hopC_10
  v_and_b32 v41, 0xffff0000, v6
  v_cvt_pk_bf16_f32 v6, v42, v43
  v_lshlrev_b32 v42, 16, v6
  v_and_b32 v43, 0xffff0000, v6
  v_lshlrev_b32 v24, 16, v32
  v_and_b32 v25, 0xffff0000, v32
  v_lshlrev_b32 v26, 16, v33
  v_and_b32 v27, 0xffff0000, v33
  v_add_f32 v40, v40, v24
  v_add_f32 v41, v41, v25
  v_add_f32 v42, v42, v26
  v_add_f32 v43, v43, v27
  v_cvt_pk_bf16_f32 v40, v40, v41
  v_cvt_pk_bf16_f32 v41, v42, v43
L_hopC_10:
  s_cbranch_execz L_hopC_11
  v_mul_u32_u24 v6, 1280, v12
  v_lshl_add_u32 v6, v13, 3, v6
  s_lshl_b32 s45, s92, 5
  s_mov_b32 exec_lo, 0xffff
  s_mov_b32 exec_hi, 0
  buffer_store_dwordx2 v[40:41], v6, s[36:39], s45 offen
  s_mov_b64 exec, -1
L_dn_done:
L_hopC_11:
  s_cbranch_execz L_warm_ret
L_tail:
L_end:
  s_endpgm
.section .rodata,"a"
.p2align 6
.amdhsa_kernel adaLN_cond__gqa_block_cached__glu_gated_bilinear__decode_kernel
  .amdhsa_next_free_vgpr 168
  .amdhsa_next_free_sgpr 102
  .amdhsa_accum_offset 168
  .amdhsa_group_segment_fixed_size 0
  .amdhsa_float_denorm_mode_32 3
  .amdhsa_kernarg_size 112
  .amdhsa_user_sgpr_count 2
  .amdhsa_user_sgpr_kernarg_segment_ptr 1
  .amdhsa_system_sgpr_workgroup_id_x 1
.end_amdhsa_kernel
```
